```python
import torch

def _softmax(x, axis=-1):
    return torch.softmax(x, dim=axis)
def _gelu(x):
    return torch.nn.functional.gelu(x, approximate="tanh")
def _silu(x):
    return torch.nn.functional.silu(x)
def _sigmoid(x):
    return torch.sigmoid(x)
def _layernorm(x, axis=-1, eps=1e-5):
    m = x.mean(dim=axis, keepdim=True)
    v = x.var(dim=axis, keepdim=True, unbiased=False)
    return (x - m) / torch.sqrt(v + eps)
def _scatter_add(tgt, idx, src, axis=0):
    return tgt.clone().index_add_(axis, idx, src)
def _segment_sum(src, seg, n):
    out = torch.zeros((n,) + src.shape[1:], dtype=src.dtype)
    return out.index_add_(0, seg, src)
def _pad(x, pw):
    flat = tuple(v for pair in reversed(pw) for v in pair)
    return torch.nn.functional.pad(x, flat)

kernel_name = 'standalone__mha_block_cached__near_ridge'

def setup_inputs():

    _w = (lambda a: (lambda t: t.to(torch.bfloat16) if t.is_floating_point() else t)(torch.as_tensor(a)))
    B, Sq, D = 8, 256, 576
    H, Sk, Dh = 32, 1024, 128
    return {
        "x": _w((lambda *s: torch.randn(*s, dtype=torch.bfloat16) * 0.8)(B, Sq, D)),
        "k_cache": _w((lambda *s: torch.randn(*s, dtype=torch.bfloat16) * 0.8)(B, H, Sk, Dh)),
        "v_cache": _w((lambda *s: torch.randn(*s, dtype=torch.bfloat16) * 0.05)(B, H, Sk, Dh)),
        "wq": _w((lambda *s: torch.randn(*s, dtype=torch.bfloat16) * 0.8)(D, H * Dh) * (D ** -0.5)),
        "wo": _w((lambda *s: torch.randn(*s, dtype=torch.bfloat16) * 0.05)(H * Dh, D) * ((H * Dh) ** -0.5)),
    }

def reference(x, k_cache, v_cache, wq, wo):
    B, Sq, D = x.shape
    H, Dh = 32, 128
    q = (lambda x, *d: x.permute(*d))((x @ wq).reshape(B, Sq, H, Dh), 0, 2, 1, 3)
    scores = torch.einsum("bhqd,bhkd->bhqk", q, k_cache) * (Dh ** -0.5)
    p = _softmax(scores, axis=-1)
    o = torch.einsum("bhqk,bhkd->bhqd", p, v_cache)
    return (lambda x, *d: x.permute(*d))(o, 0, 2, 1, 3).reshape(B, Sq, H * Dh) @ wo
```

```asm
; @launch grid=(256,1,1) block=(256,1,1) lds=163840
.amdgcn_target "amdgcn-amd-amdhsa--gfx950"
.text
.globl standalone__mha_block_cached__near_ridge_kernel
.p2align 8
.type standalone__mha_block_cached__near_ridge_kernel,@function
standalone__mha_block_cached__near_ridge_kernel:
  s_cmp_ge_u32 s2, 256
  s_cbranch_scc1 L_end
  s_load_dwordx16 s[4:19], s[0:1], 0
  s_getpc_b64 s[100:101]
  v_lshlrev_b32 v234, 4, v0
  s_lshr_b32 s72, s2, 3
  s_mul_i32 s73, s72, 8192
  s_lshr_b32 s73, s73, 16
  s_mul_i32 s73, s73, 8
  s_sub_u32 s72, s72, s73
  s_lshl_b32 s72, s72, 12
  v_add_u32 v234, s72, v234
  global_load_dwordx4 v[252:255], v234, s[100:101]
  s_and_b32 s70, s2, 7
  s_lshr_b32 s71, s2, 3
  s_and_b32 s52, s71, 3
  s_and_b32 s72, s70, 1
  s_lshl_b32 s72, s72, 2
  s_add_u32 s52, s52, s72
  s_lshr_b32 s71, s71, 2
  s_lshr_b32 s70, s70, 1
  s_lshl_b32 s53, s70, 3
  s_add_u32 s53, s53, s71
  s_lshr_b32 s55, s53, 3
  s_and_b32 s56, s53, 7
  s_and_b32 s57, s56, 1
  s_lshr_b32 s58, s56, 1
  s_and_b32 s70, s52, 3
  s_mul_i32 s70, s70, 1
  s_lshr_b32 s71, s56, 1
  s_mul_i32 s71, s71, 1
  s_add_u32 s70, s70, s71
  s_mul_i32 s71, s70, 57
  s_lshr_b32 s71, s71, 9
  s_mul_i32 s71, s71, 9
  s_sub_u32 s63, s70, s71
  v_lshrrev_b32 v241, 6, v0
  v_and_b32 v236, 63, v0
  v_readfirstlane_b32 s54, v241
  v_and_b32 v237, 15, v236
  v_lshrrev_b32 v238, 4, v236
  v_and_b32 v239, 3, v236
  v_bfe_u32 v240, v236, 2, 2
  v_lshlrev_b32 v208, 4, v236
  v_lshrrev_b32 v241, 3, v236
  s_lshl_b32 s70, s54, 6
  v_add_u32 v241, s70, v241
  v_mul_u32_u24 v241, 1152, v241
  v_and_b32 v242, 7, v236
  v_add_u32 v243, 0, v238
  v_xor_b32 v243, v243, v242
  v_lshl_add_u32 v243, v243, 4, v241
  v_add_u32 v209, 0, v243
  v_add_u32 v211, 16384, v243
  v_add_u32 v213, 36864, v243
  v_add_u32 v215, 53248, v243
  v_add_u32 v243, 4, v238
  v_xor_b32 v243, v243, v242
  v_lshl_add_u32 v243, v243, 4, v241
  v_add_u32 v210, 8192, v243
  v_add_u32 v212, 24576, v243
  v_add_u32 v214, 45056, v243
  v_add_u32 v216, 61440, v243
  s_lshl_b32 s70, s54, 4
  v_add_u32 v241, s70, v238
  v_lshlrev_b32 v241, 13, v241
  v_lshlrev_b32 v243, 1, v238
  v_xor_b32 v243, v243, v237
  v_lshl_add_u32 v243, v243, 4, v241
  v_add_u32 v217, 0, v243
  v_add_u32 v218, 31744, v243
  v_lshlrev_b32 v243, 1, v238
  v_or_b32 v243, 8, v243
  v_xor_b32 v243, v243, v237
  v_lshl_add_u32 v243, v243, 4, v241
  v_add_u32 v219, 63488, v243
  v_add_u32 v220, 95232, v243
  s_waitcnt lgkmcnt(0)
  s_mul_i32 s70, s52, 294912
  s_add_u32 s20, s4, s70
  s_addc_u32 s21, s5, 0
  s_mov_b32 s22, 294912
  s_mov_b32 s23, 0x20000
  s_lshl_b32 s70, s53, 8
  s_add_u32 s24, s10, s70
  s_addc_u32 s25, s11, 0
  s_sub_u32 s26, 4718592, s70
  s_mov_b32 s27, 0x20000
  s_lshl_b32 s65, s54, 13
  s_lshl_b32 s66, s54, 12
  s_add_u32 s66, s66, 32768
  s_lshl_b32 s59, s63, 7
  s_lshl_b32 s60, s63, 19
  s_mov_b32 s61, 16384
  s_add_u32 m0, s61, s65
  s_nop 0
  buffer_load_dwordx4 v209, s[20:23], s59 offen offset:0  lds
  buffer_load_dwordx4 v210, s[20:23], s59 offen offset:1024  lds
  buffer_load_dwordx4 v211, s[20:23], s59 offen offset:2048  lds
  buffer_load_dwordx4 v212, s[20:23], s59 offen offset:3072  lds
  s_add_u32 m0, m0, 4096
  s_nop 0
  buffer_load_dwordx4 v213, s[20:23], s59 offen offset:0  lds
  buffer_load_dwordx4 v214, s[20:23], s59 offen offset:1024  lds
  buffer_load_dwordx4 v215, s[20:23], s59 offen offset:2048  lds
  buffer_load_dwordx4 v216, s[20:23], s59 offen offset:3072  lds
  s_add_u32 m0, s61, s66
  s_nop 0
  buffer_load_dwordx4 v217, s[24:27], s60 offen offset:0  lds
  buffer_load_dwordx4 v218, s[24:27], s60 offen offset:1024  lds
  buffer_load_dwordx4 v219, s[24:27], s60 offen offset:2048  lds
  buffer_load_dwordx4 v220, s[24:27], s60 offen offset:3072  lds
  s_add_u32 s63, s63, 1
  s_cmp_eq_u32 s63, 9
  s_cselect_b32 s63, 0, s63
  s_lshl_b32 s59, s63, 7
  s_lshl_b32 s60, s63, 19
  s_or_b32 s70, s54, s53
  s_cmp_lg_u32 s70, 0
  s_cbranch_scc1 L_nonce_done
  s_memrealtime s[70:71]
  s_lshl_b32 s72, s52, 3
  v_mov_b32 v246, s72
  s_waitcnt lgkmcnt(0)
  s_or_b32 s70, s70, 1
  v_mov_b32 v248, s70
  v_mov_b32 v249, s71
  s_mov_b64 exec, 1
  global_store_dwordx2 v246, v[248:249], s[16:17] sc1
  s_mov_b64 exec, -1
L_nonce_done:
  v_lshrrev_b32 v241, 1, v237
  v_lshlrev_b32 v242, 7, v237
  s_add_u32 s70, s65, 16384
  v_add_u32 v242, s70, v242
  v_add_u32 v243, 0, v238
  v_xor_b32 v243, v243, v241
  v_lshl_add_u32 v221, v243, 4, v242
  v_add_u32 v243, 4, v238
  v_xor_b32 v243, v243, v241
  v_lshl_add_u32 v222, v243, 4, v242
  v_lshl_add_u32 v241, v238, 3, v240
  v_lshlrev_b32 v242, 8, v241
  v_and_b32 v243, 1, v239
  v_lshl_add_u32 v242, v243, 3, v242
  v_add_u32 v242, 49152, v242
  v_and_b32 v241, 1, v238
  v_lshl_add_u32 v241, v241, 2, v240
  v_lshlrev_b32 v241, 1, v241
  v_lshrrev_b32 v243, 1, v239
  v_xor_b32 v241, v241, v243
  v_xor_b32 v243, 0, v241
  v_lshl_add_u32 v223, v243, 4, v242
  v_xor_b32 v243, 2, v241
  v_lshl_add_u32 v224, v243, 4, v242
  v_xor_b32 v243, 4, v241
  v_lshl_add_u32 v225, v243, 4, v242
  v_xor_b32 v243, 6, v241
  v_lshl_add_u32 v226, v243, 4, v242
  v_xor_b32 v243, 8, v241
  v_lshl_add_u32 v227, v243, 4, v242
  v_xor_b32 v243, 10, v241
  v_lshl_add_u32 v228, v243, 4, v242
  v_xor_b32 v243, 12, v241
  v_lshl_add_u32 v229, v243, 4, v242
  v_xor_b32 v243, 14, v241
  v_lshl_add_u32 v230, v243, 4, v242
  s_mov_b32 s61, 65536
  s_add_u32 m0, s61, s65
  s_nop 0
  buffer_load_dwordx4 v209, s[20:23], s59 offen offset:0  lds
  buffer_load_dwordx4 v210, s[20:23], s59 offen offset:1024  lds
  buffer_load_dwordx4 v211, s[20:23], s59 offen offset:2048  lds
  buffer_load_dwordx4 v212, s[20:23], s59 offen offset:3072  lds
  s_add_u32 m0, m0, 4096
  s_nop 0
  buffer_load_dwordx4 v213, s[20:23], s59 offen offset:0  lds
  buffer_load_dwordx4 v214, s[20:23], s59 offen offset:1024  lds
  buffer_load_dwordx4 v215, s[20:23], s59 offen offset:2048  lds
  buffer_load_dwordx4 v216, s[20:23], s59 offen offset:3072  lds
  s_add_u32 m0, s61, s66
  s_nop 0
  buffer_load_dwordx4 v217, s[24:27], s60 offen offset:0  lds
  buffer_load_dwordx4 v218, s[24:27], s60 offen offset:1024  lds
  buffer_load_dwordx4 v219, s[24:27], s60 offen offset:2048  lds
  buffer_load_dwordx4 v220, s[24:27], s60 offen offset:3072  lds
  s_add_u32 s63, s63, 1
  s_cmp_eq_u32 s63, 9
  s_cselect_b32 s63, 0, s63
  s_lshl_b32 s59, s63, 7
  s_lshl_b32 s60, s63, 19
  s_waitcnt vmcnt(12)
  s_barrier
  s_mov_b32 s61, 16384
  ds_read_b128 a[132:135], v221 offset:0
  ds_read_b64_tr_b16 a[148:149], v223 offset:0
  ds_read_b64_tr_b16 a[150:151], v223 offset:1024
  ds_read_b128 a[136:139], v221 offset:2048
  ds_read_b128 a[140:143], v221 offset:4096
  ds_read_b128 a[144:147], v221 offset:6144
  ds_read_b64_tr_b16 a[152:153], v224 offset:0
  ds_read_b64_tr_b16 a[154:155], v224 offset:1024
  ds_read_b64_tr_b16 a[156:157], v225 offset:0
  ds_read_b64_tr_b16 a[158:159], v225 offset:1024
  ds_read_b64_tr_b16 a[160:161], v226 offset:0
  ds_read_b64_tr_b16 a[162:163], v226 offset:1024
  ds_read_b64_tr_b16 a[164:165], v227 offset:0
  ds_read_b64_tr_b16 a[166:167], v227 offset:1024
  ds_read_b64_tr_b16 a[168:169], v228 offset:0
  ds_read_b64_tr_b16 a[170:171], v228 offset:1024
  ds_read_b64_tr_b16 a[172:173], v229 offset:0
  ds_read_b64_tr_b16 a[174:175], v229 offset:1024
  ds_read_b64_tr_b16 a[176:177], v230 offset:0
  ds_read_b64_tr_b16 a[178:179], v230 offset:1024
  s_mov_b32 s3, 114688
  s_waitcnt lgkmcnt(0)
  v_mfma_f32_16x16x32_bf16 v[0:3], a[148:151], a[132:135], 0
  ds_read_b128 a[180:183], v222 offset:0
  v_and_b32 v241, 7, v237
  v_lshlrev_b32 v241, 1, v241
  v_mfma_f32_16x16x32_bf16 v[32:35], a[148:151], a[136:139], 0
  ds_read_b64_tr_b16 a[196:197], v223 offset:8192
  s_add_u32 m0, s3, s65
  v_lshlrev_b32 v242, 8, v237
  v_add_u32 v243, 0, v238
  v_mfma_f32_16x16x32_bf16 v[64:67], a[148:151], a[140:143], 0
  ds_read_b64_tr_b16 a[198:199], v223 offset:9216
  buffer_load_dwordx4 v209, s[20:23], s59 offen offset:0  lds
  v_xor_b32 v243, v243, v241
  v_lshl_add_u32 v184, v243, 4, v242
  v_mfma_f32_16x16x32_bf16 v[96:99], a[148:151], a[144:147], 0
  ds_read_b128 a[184:187], v222 offset:2048
  v_add_u32 v243, 4, v238
  v_xor_b32 v243, v243, v241
  v_mfma_f32_16x16x32_bf16 v[4:7], a[152:155], a[132:135], 0
  ds_read_b128 a[188:191], v222 offset:4096
  buffer_load_dwordx4 v210, s[20:23], s59 offen offset:1024  lds
  v_lshl_add_u32 v185, v243, 4, v242
  v_add_u32 v243, 8, v238
  v_mfma_f32_16x16x32_bf16 v[36:39], a[152:155], a[136:139], 0
  ds_read_b128 a[192:195], v222 offset:6144
  v_xor_b32 v243, v243, v241
  v_lshl_add_u32 v186, v243, 4, v242
  v_mfma_f32_16x16x32_bf16 v[68:71], a[152:155], a[140:143], 0
  ds_read_b64_tr_b16 a[200:201], v224 offset:8192
  buffer_load_dwordx4 v211, s[20:23], s59 offen offset:2048  lds
  v_add_u32 v243, 12, v238
  v_xor_b32 v243, v243, v241
  v_mfma_f32_16x16x32_bf16 v[100:103], a[152:155], a[144:147], 0
  ds_read_b64_tr_b16 a[202:203], v224 offset:9216
  v_lshl_add_u32 v187, v243, 4, v242
  v_lshl_add_u32 v241, v238, 2, v240
  v_mfma_f32_16x16x32_bf16 v[8:11], a[156:159], a[132:135], 0
  ds_read_b64_tr_b16 a[204:205], v225 offset:8192
  buffer_load_dwordx4 v212, s[20:23], s59 offen offset:3072  lds
  v_lshlrev_b32 v242, 8, v241
  v_and_b32 v241, 7, v241
  v_mfma_f32_16x16x32_bf16 v[40:43], a[156:159], a[136:139], 0
  ds_read_b64_tr_b16 a[206:207], v225 offset:9216
  v_lshlrev_b32 v241, 1, v241
  v_and_b32 v243, 1, v239
  v_mfma_f32_16x16x32_bf16 v[72:75], a[156:159], a[140:143], 0
  ds_read_b64_tr_b16 a[208:209], v226 offset:8192
  s_add_u32 m0, m0, 4096
  v_lshl_add_u32 v242, v243, 3, v242
  v_lshrrev_b32 v243, 1, v239
  v_mfma_f32_16x16x32_bf16 v[104:107], a[156:159], a[144:147], 0
  ds_read_b64_tr_b16 a[210:211], v226 offset:9216
  buffer_load_dwordx4 v213, s[20:23], s59 offen offset:0  lds
  v_xor_b32 v241, v241, v243
  v_xor_b32 v243, 0, v241
  v_mfma_f32_16x16x32_bf16 v[12:15], a[160:163], a[132:135], 0
  ds_read_b64_tr_b16 a[212:213], v227 offset:8192
  v_lshl_add_u32 v188, v243, 4, v242
  v_xor_b32 v243, 2, v241
  v_mfma_f32_16x16x32_bf16 v[44:47], a[160:163], a[136:139], 0
  ds_read_b64_tr_b16 a[214:215], v227 offset:9216
  buffer_load_dwordx4 v214, s[20:23], s59 offen offset:1024  lds
  v_lshl_add_u32 v189, v243, 4, v242
  v_xor_b32 v243, 4, v241
  v_mfma_f32_16x16x32_bf16 v[76:79], a[160:163], a[140:143], 0
  ds_read_b64_tr_b16 a[216:217], v228 offset:8192
  v_lshl_add_u32 v190, v243, 4, v242
  v_xor_b32 v243, 6, v241
  v_mfma_f32_16x16x32_bf16 v[108:111], a[160:163], a[144:147], 0
  ds_read_b64_tr_b16 a[218:219], v228 offset:9216
  buffer_load_dwordx4 v215, s[20:23], s59 offen offset:2048  lds
  v_lshl_add_u32 v191, v243, 4, v242
  v_xor_b32 v243, 8, v241
  v_mfma_f32_16x16x32_bf16 v[16:19], a[164:167], a[132:135], 0
  ds_read_b64_tr_b16 a[220:221], v229 offset:8192
  v_lshl_add_u32 v192, v243, 4, v242
  v_xor_b32 v243, 10, v241
  v_mfma_f32_16x16x32_bf16 v[48:51], a[164:167], a[136:139], 0
  ds_read_b64_tr_b16 a[222:223], v229 offset:9216
  buffer_load_dwordx4 v216, s[20:23], s59 offen offset:3072  lds
  v_lshl_add_u32 v193, v243, 4, v242
  v_xor_b32 v243, 12, v241
  v_mfma_f32_16x16x32_bf16 v[80:83], a[164:167], a[140:143], 0
  ds_read_b64_tr_b16 a[224:225], v230 offset:8192
  v_lshl_add_u32 v194, v243, 4, v242
  v_xor_b32 v243, 14, v241
  v_mfma_f32_16x16x32_bf16 v[112:115], a[164:167], a[144:147], 0
  ds_read_b64_tr_b16 a[226:227], v230 offset:9216
  s_add_u32 m0, s3, s66
  v_lshl_add_u32 v195, v243, 4, v242
  v_lshlrev_b32 v242, 8, v238
  v_mfma_f32_16x16x32_bf16 v[20:23], a[168:171], a[132:135], 0
  buffer_load_dwordx4 v217, s[24:27], s60 offen offset:0  lds
  v_add_u32 v243, 0, v238
  v_lshlrev_b32 v243, 1, v243
  v_mfma_f32_16x16x32_bf16 v[52:55], a[168:171], a[136:139], 0
  v_xor_b32 v243, v243, v237
  v_lshl_add_u32 v196, v243, 4, v242
  v_mfma_f32_16x16x32_bf16 v[84:87], a[168:171], a[140:143], 0
  buffer_load_dwordx4 v218, s[24:27], s60 offen offset:1024  lds
  v_add_u32 v243, 4, v238
  v_lshlrev_b32 v243, 1, v243
  v_mfma_f32_16x16x32_bf16 v[116:119], a[168:171], a[144:147], 0
  v_xor_b32 v243, v243, v237
  v_lshl_add_u32 v197, v243, 4, v242
  v_mfma_f32_16x16x32_bf16 v[24:27], a[172:175], a[132:135], 0
  buffer_load_dwordx4 v219, s[24:27], s60 offen offset:2048  lds
  v_mov_b32 v241, 0x3f803f80
  v_accvgpr_write_b32 a228, v241
  v_mfma_f32_16x16x32_bf16 v[56:59], a[172:175], a[136:139], 0
  v_accvgpr_write_b32 a229, v241
  v_accvgpr_write_b32 a230, v241
  v_mfma_f32_16x16x32_bf16 v[88:91], a[172:175], a[140:143], 0
  buffer_load_dwordx4 v220, s[24:27], s60 offen offset:3072  lds
  v_mfma_f32_16x16x32_bf16 v[120:123], a[172:175], a[144:147], 0
  v_mfma_f32_16x16x32_bf16 v[28:31], a[176:179], a[132:135], 0
  s_add_u32 s63, s63, 1
  s_cmp_eq_u32 s63, 9
  s_cselect_b32 s63, 0, s63
  s_lshl_b32 s59, s63, 7
  s_lshl_b32 s60, s63, 19
  v_mfma_f32_16x16x32_bf16 v[60:63], a[176:179], a[136:139], 0
  v_mfma_f32_16x16x32_bf16 v[92:95], a[176:179], a[140:143], 0
  v_mfma_f32_16x16x32_bf16 v[124:127], a[176:179], a[144:147], 0
  s_waitcnt vmcnt(12) lgkmcnt(0)
  s_barrier
  s_mov_b32 s62, 49152
  s_cmp_eq_u32 s61, 114688
  s_cselect_b32 s62, 0xfffe8000, s62
  v_mfma_f32_16x16x32_bf16 v[0:3], a[196:199], a[180:183], v[0:3]
  s_mov_b32 s3, s61
  s_add_u32 s61, s61, s62
  v_add_u32 v221, s62, v221
  v_add_u32 v222, s62, v222
  v_mfma_f32_16x16x32_bf16 v[32:35], a[196:199], a[184:187], v[32:35]
  s_add_u32 m0, s3, s65
  v_add_u32 v223, s62, v223
  v_add_u32 v224, s62, v224
  v_mfma_f32_16x16x32_bf16 v[64:67], a[196:199], a[188:191], v[64:67]
  buffer_load_dwordx4 v209, s[20:23], s59 offen offset:0  lds
  v_add_u32 v225, s62, v225
  v_add_u32 v226, s62, v226
  v_mfma_f32_16x16x32_bf16 v[96:99], a[196:199], a[192:195], v[96:99]
  v_add_u32 v227, s62, v227
  v_add_u32 v228, s62, v228
  v_mfma_f32_16x16x32_bf16 v[4:7], a[200:203], a[180:183], v[4:7]
  v_add_u32 v229, s62, v229
  v_add_u32 v230, s62, v230
  v_mfma_f32_16x16x32_bf16 v[36:39], a[200:203], a[184:187], v[36:39]
  ds_read_b128 a[132:135], v221 offset:0
  v_mfma_f32_16x16x32_bf16 v[68:71], a[200:203], a[188:191], v[68:71]
  ds_read_b64_tr_b16 a[148:149], v223 offset:0
  buffer_load_dwordx4 v210, s[20:23], s59 offen offset:1024  lds
  v_accvgpr_write_b32 a231, v241
  v_mfma_f32_16x16x32_bf16 v[100:103], a[200:203], a[192:195], v[100:103]
  ds_read_b64_tr_b16 a[150:151], v223 offset:1024
  s_lshl_b32 s0, s52, 5
  s_add_u32 s0, s0, s53
  v_mfma_f32_16x16x32_bf16 v[8:11], a[204:207], a[180:183], v[8:11]
  ds_read_b128 a[136:139], v221 offset:2048
  s_lshl_b32 s0, s0, 18
  s_add_u32 s28, s6, s0
  s_addc_u32 s29, s7, 0
  v_mfma_f32_16x16x32_bf16 v[40:43], a[204:207], a[184:187], v[40:43]
  ds_read_b128 a[140:143], v221 offset:4096
  s_mov_b32 s30, 262144
  s_mov_b32 s31, 0x20000
  v_mfma_f32_16x16x32_bf16 v[72:75], a[204:207], a[188:191], v[72:75]
  ds_read_b128 a[144:147], v221 offset:6144
  buffer_load_dwordx4 v211, s[20:23], s59 offen offset:2048  lds
  s_add_u32 s32, s8, s0
  s_addc_u32 s33, s9, 0
  v_mfma_f32_16x16x32_bf16 v[104:107], a[204:207], a[192:195], v[104:107]
  ds_read_b64_tr_b16 a[152:153], v224 offset:0
  s_mov_b32 s34, 262144
  s_mov_b32 s35, 0x20000
  v_mfma_f32_16x16x32_bf16 v[12:15], a[208:211], a[180:183], v[12:15]
  ds_read_b64_tr_b16 a[154:155], v224 offset:1024
  s_lshl_b32 s68, s54, 11
  s_mov_b32 s67, s68
  v_mfma_f32_16x16x32_bf16 v[44:47], a[208:211], a[184:187], v[44:47]
  ds_read_b64_tr_b16 a[156:157], v225 offset:0
  s_mov_b32 s74, 0x3e0293ee
  s_mov_b32 s75, 0x3e0293ee
  v_mfma_f32_16x16x32_bf16 v[76:79], a[208:211], a[188:191], v[76:79]
  ds_read_b64_tr_b16 a[158:159], v225 offset:1024
  buffer_load_dwordx4 v212, s[20:23], s59 offen offset:3072  lds
  v_mfma_f32_16x16x32_bf16 v[108:111], a[208:211], a[192:195], v[108:111]
  ds_read_b64_tr_b16 a[160:161], v226 offset:0
  v_mfma_f32_16x16x32_bf16 v[16:19], a[212:215], a[180:183], v[16:19]
  ds_read_b64_tr_b16 a[162:163], v226 offset:1024
  v_mfma_f32_16x16x32_bf16 v[48:51], a[212:215], a[184:187], v[48:51]
  ds_read_b64_tr_b16 a[164:165], v227 offset:0
  v_mfma_f32_16x16x32_bf16 v[80:83], a[212:215], a[188:191], v[80:83]
  ds_read_b64_tr_b16 a[166:167], v227 offset:1024
  s_add_u32 m0, m0, 4096
  v_mfma_f32_16x16x32_bf16 v[112:115], a[212:215], a[192:195], v[112:115]
  ds_read_b64_tr_b16 a[168:169], v228 offset:0
  buffer_load_dwordx4 v213, s[20:23], s59 offen offset:0  lds
  v_mfma_f32_16x16x32_bf16 v[20:23], a[216:219], a[180:183], v[20:23]
  ds_read_b64_tr_b16 a[170:171], v228 offset:1024
  v_mfma_f32_16x16x32_bf16 v[52:55], a[216:219], a[184:187], v[52:55]
  ds_read_b64_tr_b16 a[172:173], v229 offset:0
  v_mfma_f32_16x16x32_bf16 v[84:87], a[216:219], a[188:191], v[84:87]
  ds_read_b64_tr_b16 a[174:175], v229 offset:1024
  v_mfma_f32_16x16x32_bf16 v[116:119], a[216:219], a[192:195], v[116:119]
  ds_read_b64_tr_b16 a[176:177], v230 offset:0
  buffer_load_dwordx4 v214, s[20:23], s59 offen offset:1024  lds
  v_mfma_f32_16x16x32_bf16 v[24:27], a[220:223], a[180:183], v[24:27]
  ds_read_b64_tr_b16 a[178:179], v230 offset:1024
  v_mfma_f32_16x16x32_bf16 v[56:59], a[220:223], a[184:187], v[56:59]
  v_mfma_f32_16x16x32_bf16 v[88:91], a[220:223], a[188:191], v[88:91]
  v_mfma_f32_16x16x32_bf16 v[120:123], a[220:223], a[192:195], v[120:123]
  v_mfma_f32_16x16x32_bf16 v[28:31], a[224:227], a[180:183], v[28:31]
  v_mfma_f32_16x16x32_bf16 v[60:63], a[224:227], a[184:187], v[60:63]
  v_mfma_f32_16x16x32_bf16 v[92:95], a[224:227], a[188:191], v[92:95]
  v_mfma_f32_16x16x32_bf16 v[124:127], a[224:227], a[192:195], v[124:127]
  s_mov_b32 s64, 5
.p2align 4
L_q:
  s_waitcnt lgkmcnt(0)
  v_mfma_f32_16x16x32_bf16 v[0:3], a[148:151], a[132:135], v[0:3]
  ds_read_b128 a[180:183], v222 offset:0
  v_mfma_f32_16x16x32_bf16 v[32:35], a[148:151], a[136:139], v[32:35]
  ds_read_b64_tr_b16 a[196:197], v223 offset:8192
  v_mfma_f32_16x16x32_bf16 v[64:67], a[148:151], a[140:143], v[64:67]
  ds_read_b64_tr_b16 a[198:199], v223 offset:9216
  v_mfma_f32_16x16x32_bf16 v[96:99], a[148:151], a[144:147], v[96:99]
  ds_read_b128 a[184:187], v222 offset:2048
  v_mfma_f32_16x16x32_bf16 v[4:7], a[152:155], a[132:135], v[4:7]
  ds_read_b128 a[188:191], v222 offset:4096
  v_mfma_f32_16x16x32_bf16 v[36:39], a[152:155], a[136:139], v[36:39]
  ds_read_b128 a[192:195], v222 offset:6144
  v_mfma_f32_16x16x32_bf16 v[68:71], a[152:155], a[140:143], v[68:71]
  ds_read_b64_tr_b16 a[200:201], v224 offset:8192
  v_mfma_f32_16x16x32_bf16 v[100:103], a[152:155], a[144:147], v[100:103]
  ds_read_b64_tr_b16 a[202:203], v224 offset:9216
  v_mfma_f32_16x16x32_bf16 v[8:11], a[156:159], a[132:135], v[8:11]
  ds_read_b64_tr_b16 a[204:205], v225 offset:8192
  v_mfma_f32_16x16x32_bf16 v[40:43], a[156:159], a[136:139], v[40:43]
  ds_read_b64_tr_b16 a[206:207], v225 offset:9216
  v_mfma_f32_16x16x32_bf16 v[72:75], a[156:159], a[140:143], v[72:75]
  ds_read_b64_tr_b16 a[208:209], v226 offset:8192
  v_mfma_f32_16x16x32_bf16 v[104:107], a[156:159], a[144:147], v[104:107]
  ds_read_b64_tr_b16 a[210:211], v226 offset:9216
  v_mfma_f32_16x16x32_bf16 v[12:15], a[160:163], a[132:135], v[12:15]
  ds_read_b64_tr_b16 a[212:213], v227 offset:8192
  v_mfma_f32_16x16x32_bf16 v[44:47], a[160:163], a[136:139], v[44:47]
  ds_read_b64_tr_b16 a[214:215], v227 offset:9216
  v_mfma_f32_16x16x32_bf16 v[76:79], a[160:163], a[140:143], v[76:79]
  ds_read_b64_tr_b16 a[216:217], v228 offset:8192
  v_mfma_f32_16x16x32_bf16 v[108:111], a[160:163], a[144:147], v[108:111]
  ds_read_b64_tr_b16 a[218:219], v228 offset:9216
  v_mfma_f32_16x16x32_bf16 v[16:19], a[164:167], a[132:135], v[16:19]
  ds_read_b64_tr_b16 a[220:221], v229 offset:8192
  v_mfma_f32_16x16x32_bf16 v[48:51], a[164:167], a[136:139], v[48:51]
  ds_read_b64_tr_b16 a[222:223], v229 offset:9216
  v_mfma_f32_16x16x32_bf16 v[80:83], a[164:167], a[140:143], v[80:83]
  ds_read_b64_tr_b16 a[224:225], v230 offset:8192
  v_mfma_f32_16x16x32_bf16 v[112:115], a[164:167], a[144:147], v[112:115]
  ds_read_b64_tr_b16 a[226:227], v230 offset:9216
  s_add_u32 s70, s3, s65
  s_add_u32 m0, s70, 4096
  v_mfma_f32_16x16x32_bf16 v[20:23], a[168:171], a[132:135], v[20:23]
  buffer_load_dwordx4 v215, s[20:23], s59 offen offset:2048  lds
  v_mfma_f32_16x16x32_bf16 v[52:55], a[168:171], a[136:139], v[52:55]
  v_mfma_f32_16x16x32_bf16 v[84:87], a[168:171], a[140:143], v[84:87]
  buffer_load_dwordx4 v216, s[20:23], s59 offen offset:3072  lds
  v_mfma_f32_16x16x32_bf16 v[116:119], a[168:171], a[144:147], v[116:119]
  v_mfma_f32_16x16x32_bf16 v[24:27], a[172:175], a[132:135], v[24:27]
  s_add_u32 m0, s3, s66
  v_mfma_f32_16x16x32_bf16 v[56:59], a[172:175], a[136:139], v[56:59]
  buffer_load_dwordx4 v217, s[24:27], s60 offen offset:0  lds
  v_mfma_f32_16x16x32_bf16 v[88:91], a[172:175], a[140:143], v[88:91]
  v_mfma_f32_16x16x32_bf16 v[120:123], a[172:175], a[144:147], v[120:123]
  buffer_load_dwordx4 v218, s[24:27], s60 offen offset:1024  lds
  v_mfma_f32_16x16x32_bf16 v[28:31], a[176:179], a[132:135], v[28:31]
  v_mfma_f32_16x16x32_bf16 v[60:63], a[176:179], a[136:139], v[60:63]
  buffer_load_dwordx4 v219, s[24:27], s60 offen offset:2048  lds
  v_mfma_f32_16x16x32_bf16 v[92:95], a[176:179], a[140:143], v[92:95]
  v_mfma_f32_16x16x32_bf16 v[124:127], a[176:179], a[144:147], v[124:127]
  buffer_load_dwordx4 v220, s[24:27], s60 offen offset:3072  lds
  s_add_u32 s63, s63, 1
  s_cmp_eq_u32 s63, 9
  s_cselect_b32 s63, 0, s63
  s_lshl_b32 s59, s63, 7
  s_lshl_b32 s60, s63, 19
  s_waitcnt vmcnt(12) lgkmcnt(0)
  s_barrier
  s_mov_b32 s62, 49152
  s_cmp_eq_u32 s61, 114688
  s_cselect_b32 s62, 0xfffe8000, s62
  v_mfma_f32_16x16x32_bf16 v[0:3], a[196:199], a[180:183], v[0:3]
  s_mov_b32 s3, s61
  s_add_u32 s61, s61, s62
  v_add_u32 v221, s62, v221
  v_add_u32 v222, s62, v222
  v_mfma_f32_16x16x32_bf16 v[32:35], a[196:199], a[184:187], v[32:35]
  s_add_u32 m0, s3, s65
  v_add_u32 v223, s62, v223
  v_add_u32 v224, s62, v224
  v_mfma_f32_16x16x32_bf16 v[64:67], a[196:199], a[188:191], v[64:67]
  buffer_load_dwordx4 v209, s[20:23], s59 offen offset:0  lds
  v_add_u32 v225, s62, v225
  v_add_u32 v226, s62, v226
  v_mfma_f32_16x16x32_bf16 v[96:99], a[196:199], a[192:195], v[96:99]
  v_add_u32 v227, s62, v227
  v_add_u32 v228, s62, v228
  v_mfma_f32_16x16x32_bf16 v[4:7], a[200:203], a[180:183], v[4:7]
  v_add_u32 v229, s62, v229
  v_add_u32 v230, s62, v230
  v_mfma_f32_16x16x32_bf16 v[36:39], a[200:203], a[184:187], v[36:39]
  ds_read_b128 a[132:135], v221 offset:0
  v_mfma_f32_16x16x32_bf16 v[68:71], a[200:203], a[188:191], v[68:71]
  ds_read_b64_tr_b16 a[148:149], v223 offset:0
  buffer_load_dwordx4 v210, s[20:23], s59 offen offset:1024  lds
  v_mfma_f32_16x16x32_bf16 v[100:103], a[200:203], a[192:195], v[100:103]
  ds_read_b64_tr_b16 a[150:151], v223 offset:1024
  v_mfma_f32_16x16x32_bf16 v[8:11], a[204:207], a[180:183], v[8:11]
  ds_read_b128 a[136:139], v221 offset:2048
  v_mfma_f32_16x16x32_bf16 v[40:43], a[204:207], a[184:187], v[40:43]
  ds_read_b128 a[140:143], v221 offset:4096
  v_mfma_f32_16x16x32_bf16 v[72:75], a[204:207], a[188:191], v[72:75]
  ds_read_b128 a[144:147], v221 offset:6144
  buffer_load_dwordx4 v211, s[20:23], s59 offen offset:2048  lds
  v_mfma_f32_16x16x32_bf16 v[104:107], a[204:207], a[192:195], v[104:107]
  ds_read_b64_tr_b16 a[152:153], v224 offset:0
  v_mfma_f32_16x16x32_bf16 v[12:15], a[208:211], a[180:183], v[12:15]
  ds_read_b64_tr_b16 a[154:155], v224 offset:1024
  v_mfma_f32_16x16x32_bf16 v[44:47], a[208:211], a[184:187], v[44:47]
  ds_read_b64_tr_b16 a[156:157], v225 offset:0
  v_mfma_f32_16x16x32_bf16 v[76:79], a[208:211], a[188:191], v[76:79]
  ds_read_b64_tr_b16 a[158:159], v225 offset:1024
  buffer_load_dwordx4 v212, s[20:23], s59 offen offset:3072  lds
  v_mfma_f32_16x16x32_bf16 v[108:111], a[208:211], a[192:195], v[108:111]
  ds_read_b64_tr_b16 a[160:161], v226 offset:0
  v_mfma_f32_16x16x32_bf16 v[16:19], a[212:215], a[180:183], v[16:19]
  ds_read_b64_tr_b16 a[162:163], v226 offset:1024
  v_mfma_f32_16x16x32_bf16 v[48:51], a[212:215], a[184:187], v[48:51]
  ds_read_b64_tr_b16 a[164:165], v227 offset:0
  v_mfma_f32_16x16x32_bf16 v[80:83], a[212:215], a[188:191], v[80:83]
  ds_read_b64_tr_b16 a[166:167], v227 offset:1024
  s_add_u32 m0, m0, 4096
  v_mfma_f32_16x16x32_bf16 v[112:115], a[212:215], a[192:195], v[112:115]
  ds_read_b64_tr_b16 a[168:169], v228 offset:0
  buffer_load_dwordx4 v213, s[20:23], s59 offen offset:0  lds
  v_mfma_f32_16x16x32_bf16 v[20:23], a[216:219], a[180:183], v[20:23]
  ds_read_b64_tr_b16 a[170:171], v228 offset:1024
  v_mfma_f32_16x16x32_bf16 v[52:55], a[216:219], a[184:187], v[52:55]
  ds_read_b64_tr_b16 a[172:173], v229 offset:0
  v_mfma_f32_16x16x32_bf16 v[84:87], a[216:219], a[188:191], v[84:87]
  ds_read_b64_tr_b16 a[174:175], v229 offset:1024
  v_mfma_f32_16x16x32_bf16 v[116:119], a[216:219], a[192:195], v[116:119]
  ds_read_b64_tr_b16 a[176:177], v230 offset:0
  buffer_load_dwordx4 v214, s[20:23], s59 offen offset:1024  lds
  v_mfma_f32_16x16x32_bf16 v[24:27], a[220:223], a[180:183], v[24:27]
  ds_read_b64_tr_b16 a[178:179], v230 offset:1024
  v_mfma_f32_16x16x32_bf16 v[56:59], a[220:223], a[184:187], v[56:59]
  v_mfma_f32_16x16x32_bf16 v[88:91], a[220:223], a[188:191], v[88:91]
  v_mfma_f32_16x16x32_bf16 v[120:123], a[220:223], a[192:195], v[120:123]
  v_mfma_f32_16x16x32_bf16 v[28:31], a[224:227], a[180:183], v[28:31]
  v_mfma_f32_16x16x32_bf16 v[60:63], a[224:227], a[184:187], v[60:63]
  v_mfma_f32_16x16x32_bf16 v[92:95], a[224:227], a[188:191], v[92:95]
  v_mfma_f32_16x16x32_bf16 v[124:127], a[224:227], a[192:195], v[124:127]
  s_sub_u32 s64, s64, 1
  s_cmp_lg_u32 s64, 0
  s_cbranch_scc1 L_q
  s_waitcnt lgkmcnt(0)
  v_mfma_f32_16x16x32_bf16 v[0:3], a[148:151], a[132:135], v[0:3]
  ds_read_b128 a[180:183], v222 offset:0
  v_add_u32 v241, 0, v236
  v_mul_u32_u24 v242, 3641, v241
  v_mfma_f32_16x16x32_bf16 v[32:35], a[148:151], a[136:139], v[32:35]
  ds_read_b64_tr_b16 a[196:197], v223 offset:8192
  v_lshrrev_b32 v242, 16, v242
  v_mul_u32_u24 v243, 18, v242
  v_mfma_f32_16x16x32_bf16 v[64:67], a[148:151], a[140:143], v[64:67]
  ds_read_b64_tr_b16 a[198:199], v223 offset:9216
  v_sub_u32 v243, v241, v243
  v_mul_u32_u24 v242, 1152, v242
  v_mfma_f32_16x16x32_bf16 v[96:99], a[148:151], a[144:147], v[96:99]
  ds_read_b128 a[184:187], v222 offset:2048
  v_lshl_add_u32 v242, v243, 4, v242
  v_subrev_u32 v198, 0, v242
  v_mfma_f32_16x16x32_bf16 v[4:7], a[152:155], a[132:135], v[4:7]
  ds_read_b128 a[188:191], v222 offset:4096
  v_add_u32 v241, 64, v236
  v_mul_u32_u24 v242, 3641, v241
  v_mfma_f32_16x16x32_bf16 v[36:39], a[152:155], a[136:139], v[36:39]
  ds_read_b128 a[192:195], v222 offset:6144
  v_lshrrev_b32 v242, 16, v242
  v_mul_u32_u24 v243, 18, v242
  v_mfma_f32_16x16x32_bf16 v[68:71], a[152:155], a[140:143], v[68:71]
  ds_read_b64_tr_b16 a[200:201], v224 offset:8192
  v_sub_u32 v243, v241, v243
  v_mul_u32_u24 v242, 1152, v242
  v_mfma_f32_16x16x32_bf16 v[100:103], a[152:155], a[144:147], v[100:103]
  ds_read_b64_tr_b16 a[202:203], v224 offset:9216
  v_lshl_add_u32 v242, v243, 4, v242
  v_subrev_u32 v199, 1024, v242
  v_mfma_f32_16x16x32_bf16 v[8:11], a[156:159], a[132:135], v[8:11]
  ds_read_b64_tr_b16 a[204:205], v225 offset:8192
  v_add_u32 v241, 128, v236
  v_mul_u32_u24 v242, 3641, v241
  v_mfma_f32_16x16x32_bf16 v[40:43], a[156:159], a[136:139], v[40:43]
  ds_read_b64_tr_b16 a[206:207], v225 offset:9216
  v_lshrrev_b32 v242, 16, v242
  v_mul_u32_u24 v243, 18, v242
  v_mfma_f32_16x16x32_bf16 v[72:75], a[156:159], a[140:143], v[72:75]
  ds_read_b64_tr_b16 a[208:209], v226 offset:8192
  v_sub_u32 v243, v241, v243
  v_mul_u32_u24 v242, 1152, v242
  v_mfma_f32_16x16x32_bf16 v[104:107], a[156:159], a[144:147], v[104:107]
  ds_read_b64_tr_b16 a[210:211], v226 offset:9216
  v_lshl_add_u32 v242, v243, 4, v242
  v_subrev_u32 v200, 2048, v242
  v_mfma_f32_16x16x32_bf16 v[12:15], a[160:163], a[132:135], v[12:15]
  ds_read_b64_tr_b16 a[212:213], v227 offset:8192
  v_add_u32 v241, 192, v236
  v_mul_u32_u24 v242, 3641, v241
  v_mfma_f32_16x16x32_bf16 v[44:47], a[160:163], a[136:139], v[44:47]
  ds_read_b64_tr_b16 a[214:215], v227 offset:9216
  v_lshrrev_b32 v242, 16, v242
  v_mul_u32_u24 v243, 18, v242
  v_mfma_f32_16x16x32_bf16 v[76:79], a[160:163], a[140:143], v[76:79]
  ds_read_b64_tr_b16 a[216:217], v228 offset:8192
  v_sub_u32 v243, v241, v243
  v_mul_u32_u24 v242, 1152, v242
  v_mfma_f32_16x16x32_bf16 v[108:111], a[160:163], a[144:147], v[108:111]
  ds_read_b64_tr_b16 a[218:219], v228 offset:9216
  v_lshl_add_u32 v242, v243, 4, v242
  v_subrev_u32 v201, 0, v242
  v_mfma_f32_16x16x32_bf16 v[16:19], a[164:167], a[132:135], v[16:19]
  ds_read_b64_tr_b16 a[220:221], v229 offset:8192
  v_add_u32 v241, 256, v236
  v_mul_u32_u24 v242, 3641, v241
  v_mfma_f32_16x16x32_bf16 v[48:51], a[164:167], a[136:139], v[48:51]
  ds_read_b64_tr_b16 a[222:223], v229 offset:9216
  v_lshrrev_b32 v242, 16, v242
  v_mul_u32_u24 v243, 18, v242
  v_mfma_f32_16x16x32_bf16 v[80:83], a[164:167], a[140:143], v[80:83]
  ds_read_b64_tr_b16 a[224:225], v230 offset:8192
  v_sub_u32 v243, v241, v243
  v_mul_u32_u24 v242, 1152, v242
  v_mfma_f32_16x16x32_bf16 v[112:115], a[164:167], a[144:147], v[112:115]
  ds_read_b64_tr_b16 a[226:227], v230 offset:9216
  s_add_u32 s70, s3, s65
  s_add_u32 m0, s70, 4096
  v_lshl_add_u32 v242, v243, 4, v242
  v_subrev_u32 v202, 1024, v242
  v_mfma_f32_16x16x32_bf16 v[20:23], a[168:171], a[132:135], v[20:23]
  buffer_load_dwordx4 v215, s[20:23], s59 offen offset:2048  lds
  v_add_u32 v241, 320, v236
  v_mul_u32_u24 v242, 3641, v241
  v_mfma_f32_16x16x32_bf16 v[52:55], a[168:171], a[136:139], v[52:55]
  v_lshrrev_b32 v242, 16, v242
  v_mul_u32_u24 v243, 18, v242
  v_mfma_f32_16x16x32_bf16 v[84:87], a[168:171], a[140:143], v[84:87]
  buffer_load_dwordx4 v216, s[20:23], s59 offen offset:3072  lds
  v_sub_u32 v243, v241, v243
  v_mul_u32_u24 v242, 1152, v242
  v_mfma_f32_16x16x32_bf16 v[116:119], a[168:171], a[144:147], v[116:119]
  v_lshl_add_u32 v242, v243, 4, v242
  v_subrev_u32 v203, 2048, v242
  v_mfma_f32_16x16x32_bf16 v[24:27], a[172:175], a[132:135], v[24:27]
  s_add_u32 m0, s3, s66
  v_add_u32 v241, 384, v236
  v_mul_u32_u24 v242, 3641, v241
  v_mfma_f32_16x16x32_bf16 v[56:59], a[172:175], a[136:139], v[56:59]
  buffer_load_dwordx4 v217, s[24:27], s60 offen offset:0  lds
  v_lshrrev_b32 v242, 16, v242
  v_mul_u32_u24 v243, 18, v242
  v_mfma_f32_16x16x32_bf16 v[88:91], a[172:175], a[140:143], v[88:91]
  v_sub_u32 v243, v241, v243
  v_mul_u32_u24 v242, 1152, v242
  v_mfma_f32_16x16x32_bf16 v[120:123], a[172:175], a[144:147], v[120:123]
  buffer_load_dwordx4 v218, s[24:27], s60 offen offset:1024  lds
  v_lshl_add_u32 v242, v243, 4, v242
  v_subrev_u32 v204, 0, v242
  v_mfma_f32_16x16x32_bf16 v[28:31], a[176:179], a[132:135], v[28:31]
  v_mfma_f32_16x16x32_bf16 v[60:63], a[176:179], a[136:139], v[60:63]
  buffer_load_dwordx4 v219, s[24:27], s60 offen offset:2048  lds
  v_mfma_f32_16x16x32_bf16 v[92:95], a[176:179], a[140:143], v[92:95]
  v_mfma_f32_16x16x32_bf16 v[124:127], a[176:179], a[144:147], v[124:127]
  buffer_load_dwordx4 v220, s[24:27], s60 offen offset:3072  lds
  s_waitcnt vmcnt(12) lgkmcnt(0)
  s_barrier
  s_mov_b32 s62, 49152
  s_cmp_eq_u32 s61, 114688
  s_cselect_b32 s62, 0xfffe8000, s62
  v_mfma_f32_16x16x32_bf16 v[0:3], a[196:199], a[180:183], v[0:3]
  s_mov_b32 s3, s61
  s_add_u32 s61, s61, s62
  v_add_u32 v221, s62, v221
  v_add_u32 v222, s62, v222
  v_mfma_f32_16x16x32_bf16 v[32:35], a[196:199], a[184:187], v[32:35]
  s_add_u32 m0, s68, 0
  v_add_u32 v223, s62, v223
  v_add_u32 v224, s62, v224
  v_mfma_f32_16x16x32_bf16 v[64:67], a[196:199], a[188:191], v[64:67]
  buffer_load_dwordx4 v196, s[28:31], s67 offen offset:0 nt lds
  v_add_u32 v225, s62, v225
  v_add_u32 v226, s62, v226
  v_mfma_f32_16x16x32_bf16 v[96:99], a[196:199], a[192:195], v[96:99]
  v_add_u32 v227, s62, v227
  v_add_u32 v228, s62, v228
  v_mfma_f32_16x16x32_bf16 v[4:7], a[200:203], a[180:183], v[4:7]
  v_add_u32 v229, s62, v229
  v_add_u32 v230, s62, v230
  v_mfma_f32_16x16x32_bf16 v[36:39], a[200:203], a[184:187], v[36:39]
  ds_read_b128 a[132:135], v221 offset:0
  v_mfma_f32_16x16x32_bf16 v[68:71], a[200:203], a[188:191], v[68:71]
  ds_read_b64_tr_b16 a[148:149], v223 offset:0
  buffer_load_dwordx4 v197, s[28:31], s67 offen offset:1024 nt lds
  v_add_u32 v241, 448, v236
  v_mul_u32_u24 v242, 3641, v241
  v_mfma_f32_16x16x32_bf16 v[100:103], a[200:203], a[192:195], v[100:103]
  ds_read_b64_tr_b16 a[150:151], v223 offset:1024
  v_lshrrev_b32 v242, 16, v242
  v_mul_u32_u24 v243, 18, v242
  v_mfma_f32_16x16x32_bf16 v[8:11], a[204:207], a[180:183], v[8:11]
  ds_read_b128 a[136:139], v221 offset:2048
  v_sub_u32 v243, v241, v243
  v_mul_u32_u24 v242, 1152, v242
  v_mfma_f32_16x16x32_bf16 v[40:43], a[204:207], a[184:187], v[40:43]
  ds_read_b128 a[140:143], v221 offset:4096
  v_lshl_add_u32 v242, v243, 4, v242
  v_subrev_u32 v205, 1024, v242
  v_mfma_f32_16x16x32_bf16 v[72:75], a[204:207], a[188:191], v[72:75]
  ds_read_b128 a[144:147], v221 offset:6144
  s_mov_b32 s69, s67
  s_add_u32 s67, s67, 8192
  s_add_u32 m0, s68, 16384
  v_add_u32 v241, 512, v236
  v_mul_u32_u24 v242, 3641, v241
  v_mfma_f32_16x16x32_bf16 v[104:107], a[204:207], a[192:195], v[104:107]
  ds_read_b64_tr_b16 a[152:153], v224 offset:0
  buffer_load_dwordx4 v196, s[28:31], s67 offen offset:0 nt lds
  v_lshrrev_b32 v242, 16, v242
  v_mul_u32_u24 v243, 18, v242
  v_mfma_f32_16x16x32_bf16 v[12:15], a[208:211], a[180:183], v[12:15]
  ds_read_b64_tr_b16 a[154:155], v224 offset:1024
  v_sub_u32 v243, v241, v243
  v_mul_u32_u24 v242, 1152, v242
  v_mfma_f32_16x16x32_bf16 v[44:47], a[208:211], a[184:187], v[44:47]
  ds_read_b64_tr_b16 a[156:157], v225 offset:0
  v_lshl_add_u32 v242, v243, 4, v242
  v_subrev_u32 v206, 2048, v242
  v_mfma_f32_16x16x32_bf16 v[76:79], a[208:211], a[188:191], v[76:79]
  ds_read_b64_tr_b16 a[158:159], v225 offset:1024
  v_lshl_add_u32 v241, v238, 2, v240
  v_mul_u32_u24 v241, 288, v241
  v_mfma_f32_16x16x32_bf16 v[108:111], a[208:211], a[192:195], v[108:111]
  ds_read_b64_tr_b16 a[160:161], v226 offset:0
  buffer_load_dwordx4 v197, s[28:31], s67 offen offset:1024 nt lds
  v_lshl_add_u32 v207, v239, 3, v241
  v_mfma_f32_16x16x32_bf16 v[16:19], a[212:215], a[180:183], v[16:19]
  ds_read_b64_tr_b16 a[162:163], v226 offset:1024
  v_mfma_f32_16x16x32_bf16 v[48:51], a[212:215], a[184:187], v[48:51]
  ds_read_b64_tr_b16 a[164:165], v227 offset:0
  v_mfma_f32_16x16x32_bf16 v[80:83], a[212:215], a[188:191], v[80:83]
  ds_read_b64_tr_b16 a[166:167], v227 offset:1024
  v_mfma_f32_16x16x32_bf16 v[112:115], a[212:215], a[192:195], v[112:115]
  ds_read_b64_tr_b16 a[168:169], v228 offset:0
  s_add_u32 m0, s68, 24576
  v_mfma_f32_16x16x32_bf16 v[20:23], a[216:219], a[180:183], v[20:23]
  ds_read_b64_tr_b16 a[170:171], v228 offset:1024
  buffer_load_dwordx4 v196, s[32:35], s69 offen offset:0 nt lds
  v_mfma_f32_16x16x32_bf16 v[52:55], a[216:219], a[184:187], v[52:55]
  ds_read_b64_tr_b16 a[172:173], v229 offset:0
  v_mfma_f32_16x16x32_bf16 v[84:87], a[216:219], a[188:191], v[84:87]
  ds_read_b64_tr_b16 a[174:175], v229 offset:1024
  v_mfma_f32_16x16x32_bf16 v[116:119], a[216:219], a[192:195], v[116:119]
  ds_read_b64_tr_b16 a[176:177], v230 offset:0
  v_mfma_f32_16x16x32_bf16 v[24:27], a[220:223], a[180:183], v[24:27]
  ds_read_b64_tr_b16 a[178:179], v230 offset:1024
  buffer_load_dwordx4 v197, s[32:35], s69 offen offset:1024 nt lds
  v_mfma_f32_16x16x32_bf16 v[56:59], a[220:223], a[184:187], v[56:59]
  v_mfma_f32_16x16x32_bf16 v[88:91], a[220:223], a[188:191], v[88:91]
  v_mfma_f32_16x16x32_bf16 v[120:123], a[220:223], a[192:195], v[120:123]
  v_mfma_f32_16x16x32_bf16 v[28:31], a[224:227], a[180:183], v[28:31]
  s_mov_b32 s69, s67
  s_add_u32 s67, s67, 8192
  v_mfma_f32_16x16x32_bf16 v[60:63], a[224:227], a[184:187], v[60:63]
  v_mfma_f32_16x16x32_bf16 v[92:95], a[224:227], a[188:191], v[92:95]
  v_mfma_f32_16x16x32_bf16 v[124:127], a[224:227], a[192:195], v[124:127]
  s_waitcnt lgkmcnt(0)
  v_mfma_f32_16x16x32_bf16 v[0:3], a[148:151], a[132:135], v[0:3]
  ds_read_b128 a[180:183], v222 offset:0
  s_mov_b32 s36, s12
  s_mov_b32 s37, s13
  v_mfma_f32_16x16x32_bf16 v[32:35], a[148:151], a[136:139], v[32:35]
  ds_read_b64_tr_b16 a[196:197], v223 offset:8192
  s_mov_b32 s38, 4718592
  s_mov_b32 s39, 0x20000
  v_mfma_f32_16x16x32_bf16 v[64:67], a[148:151], a[140:143], v[64:67]
  ds_read_b64_tr_b16 a[198:199], v223 offset:9216
  s_lshl_b32 s0, s52, 21
  s_add_u32 s40, s18, s0
  s_addc_u32 s41, s19, 0
  v_mfma_f32_16x16x32_bf16 v[96:99], a[148:151], a[144:147], v[96:99]
  ds_read_b128 a[184:187], v222 offset:2048
  s_mov_b32 s42, 0x200000
  s_mov_b32 s43, 0x20000
  v_mfma_f32_16x16x32_bf16 v[4:7], a[152:155], a[132:135], v[4:7]
  ds_read_b128 a[188:191], v222 offset:4096
  s_lshl_b32 s0, s52, 3
  s_lshl_b32 s1, s57, 2
  v_mfma_f32_16x16x32_bf16 v[36:39], a[152:155], a[136:139], v[36:39]
  ds_read_b128 a[192:195], v222 offset:6144
  s_add_u32 s0, s0, s1
  s_add_u32 s0, s0, s58
  v_mfma_f32_16x16x32_bf16 v[68:71], a[152:155], a[140:143], v[68:71]
  ds_read_b64_tr_b16 a[200:201], v224 offset:8192
  s_mul_i32 s0, s0, 294912
  s_add_u32 s0, s0, 17825792
  v_mfma_f32_16x16x32_bf16 v[100:103], a[152:155], a[144:147], v[100:103]
  ds_read_b64_tr_b16 a[202:203], v224 offset:9216
  s_add_u32 s44, s18, s0
  s_addc_u32 s45, s19, 0
  v_mfma_f32_16x16x32_bf16 v[8:11], a[156:159], a[132:135], v[8:11]
  ds_read_b64_tr_b16 a[204:205], v225 offset:8192
  s_mov_b32 s46, 294912
  s_mov_b32 s47, 0x20000
  v_mfma_f32_16x16x32_bf16 v[40:43], a[156:159], a[136:139], v[40:43]
  ds_read_b64_tr_b16 a[206:207], v225 offset:9216
  s_mul_i32 s0, s52, 294912
  s_add_u32 s48, s14, s0
  s_addc_u32 s49, s15, 0
  v_mfma_f32_16x16x32_bf16 v[72:75], a[156:159], a[140:143], v[72:75]
  ds_read_b64_tr_b16 a[208:209], v226 offset:8192
  s_mov_b32 s50, 294912
  s_mov_b32 s51, 0x20000
  v_mfma_f32_16x16x32_bf16 v[104:107], a[156:159], a[144:147], v[104:107]
  ds_read_b64_tr_b16 a[210:211], v226 offset:9216
  s_lshl_b32 s0, s54, 5
  s_lshl_b32 s1, s55, 10
  v_mfma_f32_16x16x32_bf16 v[12:15], a[160:163], a[132:135], v[12:15]
  ds_read_b64_tr_b16 a[212:213], v227 offset:8192
  s_add_u32 s0, s0, s1
  s_mul_i32 s0, s0, 1152
  v_mfma_f32_16x16x32_bf16 v[44:47], a[160:163], a[136:139], v[44:47]
  ds_read_b64_tr_b16 a[214:215], v227 offset:9216
  s_mul_i32 s1, s58, 288
  s_add_u32 s76, s0, s1
  v_mfma_f32_16x16x32_bf16 v[76:79], a[160:163], a[140:143], v[76:79]
  ds_read_b64_tr_b16 a[216:217], v228 offset:8192
  s_and_b32 s6, s52, 3
  s_lshl_b32 s6, s6, 1
  v_mfma_f32_16x16x32_bf16 v[108:111], a[160:163], a[144:147], v[108:111]
  ds_read_b64_tr_b16 a[218:219], v228 offset:9216
  s_mov_b32 s7, 0
  v_mfma_f32_16x16x32_bf16 v[16:19], a[164:167], a[132:135], v[16:19]
  ds_read_b64_tr_b16 a[220:221], v229 offset:8192
  v_mfma_f32_16x16x32_bf16 v[48:51], a[164:167], a[136:139], v[48:51]
  ds_read_b64_tr_b16 a[222:223], v229 offset:9216
  v_mfma_f32_16x16x32_bf16 v[80:83], a[164:167], a[140:143], v[80:83]
  ds_read_b64_tr_b16 a[224:225], v230 offset:8192
  v_mfma_f32_16x16x32_bf16 v[112:115], a[164:167], a[144:147], v[112:115]
  ds_read_b64_tr_b16 a[226:227], v230 offset:9216
  s_add_u32 m0, s68, 32768
  v_mfma_f32_16x16x32_bf16 v[20:23], a[168:171], a[132:135], v[20:23]
  buffer_load_dwordx4 v196, s[28:31], s67 offen offset:0 nt lds
  v_mfma_f32_16x16x32_bf16 v[52:55], a[168:171], a[136:139], v[52:55]
  v_mfma_f32_16x16x32_bf16 v[84:87], a[168:171], a[140:143], v[84:87]
  buffer_load_dwordx4 v197, s[28:31], s67 offen offset:1024 nt lds
  v_mfma_f32_16x16x32_bf16 v[116:119], a[168:171], a[144:147], v[116:119]
  v_mfma_f32_16x16x32_bf16 v[24:27], a[172:175], a[132:135], v[24:27]
  s_add_u32 m0, s68, 40960
  v_mfma_f32_16x16x32_bf16 v[56:59], a[172:175], a[136:139], v[56:59]
  buffer_load_dwordx4 v196, s[32:35], s69 offen offset:0 nt lds
  v_mfma_f32_16x16x32_bf16 v[88:91], a[172:175], a[140:143], v[88:91]
  v_mfma_f32_16x16x32_bf16 v[120:123], a[172:175], a[144:147], v[120:123]
  buffer_load_dwordx4 v197, s[32:35], s69 offen offset:1024 nt lds
  v_mfma_f32_16x16x32_bf16 v[28:31], a[176:179], a[132:135], v[28:31]
  v_mfma_f32_16x16x32_bf16 v[60:63], a[176:179], a[136:139], v[60:63]
  s_mov_b32 s69, s67
  s_add_u32 s67, s67, 8192
  v_mfma_f32_16x16x32_bf16 v[92:95], a[176:179], a[140:143], v[92:95]
  v_mfma_f32_16x16x32_bf16 v[124:127], a[176:179], a[144:147], v[124:127]
  s_waitcnt vmcnt(10) lgkmcnt(0)
  s_barrier
  s_mov_b32 s62, 49152
  s_cmp_eq_u32 s61, 114688
  s_cselect_b32 s62, 0xfffe8000, s62
  v_mfma_f32_16x16x32_bf16 v[0:3], a[196:199], a[180:183], v[0:3]
  s_mov_b32 s3, s61
  s_add_u32 s61, s61, s62
  v_add_u32 v221, s62, v221
  v_add_u32 v222, s62, v222
  v_mfma_f32_16x16x32_bf16 v[32:35], a[196:199], a[184:187], v[32:35]
  s_add_u32 m0, s68, 49152
  v_add_u32 v223, s62, v223
  v_add_u32 v224, s62, v224
  v_mfma_f32_16x16x32_bf16 v[64:67], a[196:199], a[188:191], v[64:67]
  buffer_load_dwordx4 v196, s[28:31], s67 offen offset:0 nt lds
  v_add_u32 v225, s62, v225
  v_add_u32 v226, s62, v226
  v_mfma_f32_16x16x32_bf16 v[96:99], a[196:199], a[192:195], v[96:99]
  v_add_u32 v227, s62, v227
  v_add_u32 v228, s62, v228
  v_mfma_f32_16x16x32_bf16 v[4:7], a[200:203], a[180:183], v[4:7]
  v_add_u32 v229, s62, v229
  v_add_u32 v230, s62, v230
  v_mfma_f32_16x16x32_bf16 v[36:39], a[200:203], a[184:187], v[36:39]
  ds_read_b128 a[132:135], v221 offset:0
  v_mfma_f32_16x16x32_bf16 v[68:71], a[200:203], a[188:191], v[68:71]
  ds_read_b64_tr_b16 a[148:149], v223 offset:0
  v_mfma_f32_16x16x32_bf16 v[100:103], a[200:203], a[192:195], v[100:103]
  ds_read_b64_tr_b16 a[150:151], v223 offset:1024
  v_mfma_f32_16x16x32_bf16 v[8:11], a[204:207], a[180:183], v[8:11]
  ds_read_b128 a[136:139], v221 offset:2048
  v_mfma_f32_16x16x32_bf16 v[40:43], a[204:207], a[184:187], v[40:43]
  ds_read_b128 a[140:143], v221 offset:4096
  buffer_load_dwordx4 v197, s[28:31], s67 offen offset:1024 nt lds
  v_mfma_f32_16x16x32_bf16 v[72:75], a[204:207], a[188:191], v[72:75]
  ds_read_b128 a[144:147], v221 offset:6144
  v_mfma_f32_16x16x32_bf16 v[104:107], a[204:207], a[192:195], v[104:107]
  ds_read_b64_tr_b16 a[152:153], v224 offset:0
  v_mfma_f32_16x16x32_bf16 v[12:15], a[208:211], a[180:183], v[12:15]
  ds_read_b64_tr_b16 a[154:155], v224 offset:1024
  v_mfma_f32_16x16x32_bf16 v[44:47], a[208:211], a[184:187], v[44:47]
  ds_read_b64_tr_b16 a[156:157], v225 offset:0
  v_mfma_f32_16x16x32_bf16 v[76:79], a[208:211], a[188:191], v[76:79]
  ds_read_b64_tr_b16 a[158:159], v225 offset:1024
  v_mfma_f32_16x16x32_bf16 v[108:111], a[208:211], a[192:195], v[108:111]
  ds_read_b64_tr_b16 a[160:161], v226 offset:0
  v_mfma_f32_16x16x32_bf16 v[16:19], a[212:215], a[180:183], v[16:19]
  ds_read_b64_tr_b16 a[162:163], v226 offset:1024
  s_add_u32 m0, s68, 57344
  v_mfma_f32_16x16x32_bf16 v[48:51], a[212:215], a[184:187], v[48:51]
  ds_read_b64_tr_b16 a[164:165], v227 offset:0
  buffer_load_dwordx4 v196, s[32:35], s69 offen offset:0 nt lds
  v_mfma_f32_16x16x32_bf16 v[80:83], a[212:215], a[188:191], v[80:83]
  ds_read_b64_tr_b16 a[166:167], v227 offset:1024
  v_mfma_f32_16x16x32_bf16 v[112:115], a[212:215], a[192:195], v[112:115]
  ds_read_b64_tr_b16 a[168:169], v228 offset:0
  v_mfma_f32_16x16x32_bf16 v[20:23], a[216:219], a[180:183], v[20:23]
  ds_read_b64_tr_b16 a[170:171], v228 offset:1024
  v_mfma_f32_16x16x32_bf16 v[52:55], a[216:219], a[184:187], v[52:55]
  ds_read_b64_tr_b16 a[172:173], v229 offset:0
  v_mfma_f32_16x16x32_bf16 v[84:87], a[216:219], a[188:191], v[84:87]
  ds_read_b64_tr_b16 a[174:175], v229 offset:1024
  v_mfma_f32_16x16x32_bf16 v[116:119], a[216:219], a[192:195], v[116:119]
  ds_read_b64_tr_b16 a[176:177], v230 offset:0
  v_mfma_f32_16x16x32_bf16 v[24:27], a[220:223], a[180:183], v[24:27]
  ds_read_b64_tr_b16 a[178:179], v230 offset:1024
  buffer_load_dwordx4 v197, s[32:35], s69 offen offset:1024 nt lds
  v_mfma_f32_16x16x32_bf16 v[56:59], a[220:223], a[184:187], v[56:59]
  v_mfma_f32_16x16x32_bf16 v[88:91], a[220:223], a[188:191], v[88:91]
  v_mfma_f32_16x16x32_bf16 v[120:123], a[220:223], a[192:195], v[120:123]
  v_mfma_f32_16x16x32_bf16 v[28:31], a[224:227], a[180:183], v[28:31]
  v_mfma_f32_16x16x32_bf16 v[60:63], a[224:227], a[184:187], v[60:63]
  v_mfma_f32_16x16x32_bf16 v[92:95], a[224:227], a[188:191], v[92:95]
  v_mfma_f32_16x16x32_bf16 v[124:127], a[224:227], a[192:195], v[124:127]
  s_mov_b32 s69, s67
  s_add_u32 s67, s67, 8192
  s_waitcnt lgkmcnt(0)
  v_mfma_f32_16x16x32_bf16 v[0:3], a[148:151], a[132:135], v[0:3]
  ds_read_b128 a[180:183], v222 offset:0
  v_mfma_f32_16x16x32_bf16 v[32:35], a[148:151], a[136:139], v[32:35]
  ds_read_b64_tr_b16 a[196:197], v223 offset:8192
  v_mfma_f32_16x16x32_bf16 v[64:67], a[148:151], a[140:143], v[64:67]
  ds_read_b64_tr_b16 a[198:199], v223 offset:9216
  v_mfma_f32_16x16x32_bf16 v[96:99], a[148:151], a[144:147], v[96:99]
  ds_read_b128 a[184:187], v222 offset:2048
  v_mfma_f32_16x16x32_bf16 v[4:7], a[152:155], a[132:135], v[4:7]
  ds_read_b128 a[188:191], v222 offset:4096
  v_mfma_f32_16x16x32_bf16 v[36:39], a[152:155], a[136:139], v[36:39]
  ds_read_b128 a[192:195], v222 offset:6144
  v_mfma_f32_16x16x32_bf16 v[68:71], a[152:155], a[140:143], v[68:71]
  ds_read_b64_tr_b16 a[200:201], v224 offset:8192
  v_mfma_f32_16x16x32_bf16 v[100:103], a[152:155], a[144:147], v[100:103]
  ds_read_b64_tr_b16 a[202:203], v224 offset:9216
  v_mfma_f32_16x16x32_bf16 v[8:11], a[156:159], a[132:135], v[8:11]
  ds_read_b64_tr_b16 a[204:205], v225 offset:8192
  v_mfma_f32_16x16x32_bf16 v[40:43], a[156:159], a[136:139], v[40:43]
  ds_read_b64_tr_b16 a[206:207], v225 offset:9216
  v_mfma_f32_16x16x32_bf16 v[72:75], a[156:159], a[140:143], v[72:75]
  ds_read_b64_tr_b16 a[208:209], v226 offset:8192
  v_mfma_f32_16x16x32_bf16 v[104:107], a[156:159], a[144:147], v[104:107]
  ds_read_b64_tr_b16 a[210:211], v226 offset:9216
  v_mfma_f32_16x16x32_bf16 v[12:15], a[160:163], a[132:135], v[12:15]
  ds_read_b64_tr_b16 a[212:213], v227 offset:8192
  v_mfma_f32_16x16x32_bf16 v[44:47], a[160:163], a[136:139], v[44:47]
  ds_read_b64_tr_b16 a[214:215], v227 offset:9216
  v_mfma_f32_16x16x32_bf16 v[76:79], a[160:163], a[140:143], v[76:79]
  ds_read_b64_tr_b16 a[216:217], v228 offset:8192
  v_mfma_f32_16x16x32_bf16 v[108:111], a[160:163], a[144:147], v[108:111]
  ds_read_b64_tr_b16 a[218:219], v228 offset:9216
  v_mfma_f32_16x16x32_bf16 v[16:19], a[164:167], a[132:135], v[16:19]
  ds_read_b64_tr_b16 a[220:221], v229 offset:8192
  v_mfma_f32_16x16x32_bf16 v[48:51], a[164:167], a[136:139], v[48:51]
  ds_read_b64_tr_b16 a[222:223], v229 offset:9216
  v_mfma_f32_16x16x32_bf16 v[80:83], a[164:167], a[140:143], v[80:83]
  ds_read_b64_tr_b16 a[224:225], v230 offset:8192
  v_mfma_f32_16x16x32_bf16 v[112:115], a[164:167], a[144:147], v[112:115]
  ds_read_b64_tr_b16 a[226:227], v230 offset:9216
  v_mfma_f32_16x16x32_bf16 v[20:23], a[168:171], a[132:135], v[20:23]
  v_mfma_f32_16x16x32_bf16 v[52:55], a[168:171], a[136:139], v[52:55]
  v_mfma_f32_16x16x32_bf16 v[84:87], a[168:171], a[140:143], v[84:87]
  v_mfma_f32_16x16x32_bf16 v[116:119], a[168:171], a[144:147], v[116:119]
  v_mfma_f32_16x16x32_bf16 v[24:27], a[172:175], a[132:135], v[24:27]
  v_mfma_f32_16x16x32_bf16 v[56:59], a[172:175], a[136:139], v[56:59]
  v_mfma_f32_16x16x32_bf16 v[88:91], a[172:175], a[140:143], v[88:91]
  v_mfma_f32_16x16x32_bf16 v[120:123], a[172:175], a[144:147], v[120:123]
  v_mfma_f32_16x16x32_bf16 v[28:31], a[176:179], a[132:135], v[28:31]
  v_mfma_f32_16x16x32_bf16 v[60:63], a[176:179], a[136:139], v[60:63]
  v_mfma_f32_16x16x32_bf16 v[92:95], a[176:179], a[140:143], v[92:95]
  v_mfma_f32_16x16x32_bf16 v[124:127], a[176:179], a[144:147], v[124:127]
  s_waitcnt vmcnt(12) lgkmcnt(0)
  s_barrier
  v_mfma_f32_16x16x32_bf16 v[0:3], a[196:199], a[180:183], v[0:3]
  v_mfma_f32_16x16x32_bf16 v[4:7], a[200:203], a[180:183], v[4:7]
  v_mfma_f32_16x16x32_bf16 v[8:11], a[204:207], a[180:183], v[8:11]
  ds_read_b128 a[64:67], v184 offset:0
  v_mfma_f32_16x16x32_bf16 v[12:15], a[208:211], a[180:183], v[12:15]
  ds_read_b128 a[68:71], v185 offset:0
  v_mfma_f32_16x16x32_bf16 v[16:19], a[212:215], a[180:183], v[16:19]
  ds_read_b128 a[72:75], v186 offset:0
  v_mfma_f32_16x16x32_bf16 v[20:23], a[216:219], a[180:183], v[20:23]
  ds_read_b128 a[76:79], v187 offset:0
  v_mfma_f32_16x16x32_bf16 v[24:27], a[220:223], a[180:183], v[24:27]
  ds_read_b128 a[80:83], v184 offset:4096
  v_mfma_f32_16x16x32_bf16 v[28:31], a[224:227], a[180:183], v[28:31]
  ds_read_b128 a[84:87], v185 offset:4096
  v_mfma_f32_16x16x32_bf16 v[32:35], a[196:199], a[184:187], v[32:35]
  ds_read_b128 a[88:91], v186 offset:4096
  v_mfma_f32_16x16x32_bf16 v[36:39], a[200:203], a[184:187], v[36:39]
  ds_read_b128 a[92:95], v187 offset:4096
  v_mfma_f32_16x16x32_bf16 v[40:43], a[204:207], a[184:187], v[40:43]
  v_pk_mul_f32 v[0:1], v[0:1], s[74:75]
  v_pk_mul_f32 v[2:3], v[2:3], s[74:75]
  v_mfma_f32_16x16x32_bf16 v[44:47], a[208:211], a[184:187], v[44:47]
  v_pk_mul_f32 v[4:5], v[4:5], s[74:75]
  v_pk_mul_f32 v[6:7], v[6:7], s[74:75]
  v_mfma_f32_16x16x32_bf16 v[48:51], a[212:215], a[184:187], v[48:51]
  v_pk_mul_f32 v[8:9], v[8:9], s[74:75]
  v_pk_mul_f32 v[10:11], v[10:11], s[74:75]
  v_mfma_f32_16x16x32_bf16 v[52:55], a[216:219], a[184:187], v[52:55]
  v_pk_mul_f32 v[12:13], v[12:13], s[74:75]
  v_pk_mul_f32 v[14:15], v[14:15], s[74:75]
  v_mfma_f32_16x16x32_bf16 v[56:59], a[220:223], a[184:187], v[56:59]
  v_cvt_pk_bf16_f32 v234, v0, v1
  v_cvt_pk_bf16_f32 v235, v2, v3
  v_mfma_f32_16x16x32_bf16 v[60:63], a[224:227], a[184:187], v[60:63]
  v_cvt_pk_bf16_f32 v236, v4, v5
  v_cvt_pk_bf16_f32 v237, v6, v7
  v_mfma_f32_16x16x32_bf16 v[64:67], a[196:199], a[188:191], v[64:67]
  v_cvt_pk_bf16_f32 v238, v8, v9
  v_cvt_pk_bf16_f32 v239, v10, v11
  v_mfma_f32_16x16x32_bf16 v[68:71], a[200:203], a[188:191], v[68:71]
  v_cvt_pk_bf16_f32 v240, v12, v13
  v_cvt_pk_bf16_f32 v241, v14, v15
  v_mfma_f32_16x16x32_bf16 v[72:75], a[204:207], a[188:191], v[72:75]
  v_permlane32_swap_b32 v234, v236
  v_permlane32_swap_b32 v235, v237
  v_mfma_f32_16x16x32_bf16 v[76:79], a[208:211], a[188:191], v[76:79]
  v_permlane32_swap_b32 v238, v240
  v_permlane32_swap_b32 v239, v241
  v_mfma_f32_16x16x32_bf16 v[80:83], a[212:215], a[188:191], v[80:83]
  v_permlane16_swap_b32 v234, v236
  v_permlane16_swap_b32 v235, v237
  v_mfma_f32_16x16x32_bf16 v[84:87], a[216:219], a[188:191], v[84:87]
  v_permlane16_swap_b32 v238, v240
  v_permlane16_swap_b32 v239, v241
  v_mfma_f32_16x16x32_bf16 v[88:91], a[220:223], a[188:191], v[88:91]
  v_accvgpr_write_b32 a0, v234
  v_accvgpr_write_b32 a1, v235
  v_mfma_f32_16x16x32_bf16 v[92:95], a[224:227], a[188:191], v[92:95]
  v_accvgpr_write_b32 a2, v236
  v_accvgpr_write_b32 a3, v237
  v_mfma_f32_16x16x32_bf16 v[96:99], a[196:199], a[192:195], v[96:99]
  v_accvgpr_write_b32 a4, v238
  v_accvgpr_write_b32 a5, v239
  v_mfma_f32_16x16x32_bf16 v[100:103], a[200:203], a[192:195], v[100:103]
  v_accvgpr_write_b32 a6, v240
  v_accvgpr_write_b32 a7, v241
  v_mfma_f32_16x16x32_bf16 v[104:107], a[204:207], a[192:195], v[104:107]
  v_pk_mul_f32 v[16:17], v[16:17], s[74:75]
  v_pk_mul_f32 v[18:19], v[18:19], s[74:75]
  v_mfma_f32_16x16x32_bf16 v[108:111], a[208:211], a[192:195], v[108:111]
  v_pk_mul_f32 v[20:21], v[20:21], s[74:75]
  v_pk_mul_f32 v[22:23], v[22:23], s[74:75]
  v_mfma_f32_16x16x32_bf16 v[112:115], a[212:215], a[192:195], v[112:115]
  v_pk_mul_f32 v[24:25], v[24:25], s[74:75]
  v_pk_mul_f32 v[26:27], v[26:27], s[74:75]
  v_mfma_f32_16x16x32_bf16 v[116:119], a[216:219], a[192:195], v[116:119]
  v_pk_mul_f32 v[28:29], v[28:29], s[74:75]
  v_pk_mul_f32 v[30:31], v[30:31], s[74:75]
  v_mfma_f32_16x16x32_bf16 v[120:123], a[220:223], a[192:195], v[120:123]
  v_cvt_pk_bf16_f32 v234, v16, v17
  v_cvt_pk_bf16_f32 v235, v18, v19
  v_mfma_f32_16x16x32_bf16 v[124:127], a[224:227], a[192:195], v[124:127]
  v_cvt_pk_bf16_f32 v236, v20, v21
  v_cvt_pk_bf16_f32 v237, v22, v23
  v_cvt_pk_bf16_f32 v238, v24, v25
  v_cvt_pk_bf16_f32 v239, v26, v27
  v_cvt_pk_bf16_f32 v240, v28, v29
  v_cvt_pk_bf16_f32 v241, v30, v31
  v_permlane32_swap_b32 v234, v236
  v_permlane32_swap_b32 v235, v237
  v_permlane32_swap_b32 v238, v240
  v_permlane32_swap_b32 v239, v241
  v_permlane16_swap_b32 v234, v236
  v_permlane16_swap_b32 v235, v237
  v_permlane16_swap_b32 v238, v240
  v_permlane16_swap_b32 v239, v241
  v_accvgpr_write_b32 a8, v234
  v_accvgpr_write_b32 a9, v235
  v_accvgpr_write_b32 a10, v236
  v_accvgpr_write_b32 a11, v237
  v_accvgpr_write_b32 a12, v238
  v_accvgpr_write_b32 a13, v239
  v_accvgpr_write_b32 a14, v240
  v_accvgpr_write_b32 a15, v241
  s_mul_i32 s72, s2, 18432
  s_mul_i32 s73, s54, 4608
  s_add_u32 s72, s72, s73
  v_lshrrev_b32 v209, 4, v208
  v_min_u32 v209, 35, v209
  v_lshlrev_b32 v209, 7, v209
  buffer_load_dword v210, v209, s[36:39], s72 offen
  s_waitcnt lgkmcnt(0)
  v_pk_mul_f32 v[32:33], v[32:33], s[74:75]
  v_pk_mul_f32 v[34:35], v[34:35], s[74:75]
  v_mfma_f32_16x16x32_bf16 v[144:147], a[64:67], a[0:3], 0
  v_pk_mul_f32 v[36:37], v[36:37], s[74:75]
  v_pk_mul_f32 v[38:39], v[38:39], s[74:75]
  v_mfma_f32_16x16x32_bf16 v[144:147], a[68:71], a[4:7], v[144:147]
  v_pk_mul_f32 v[40:41], v[40:41], s[74:75]
  v_pk_mul_f32 v[42:43], v[42:43], s[74:75]
  v_mfma_f32_16x16x32_bf16 v[144:147], a[72:75], a[8:11], v[144:147]
  v_pk_mul_f32 v[44:45], v[44:45], s[74:75]
  v_pk_mul_f32 v[46:47], v[46:47], s[74:75]
  v_mfma_f32_16x16x32_bf16 v[144:147], a[76:79], a[12:15], v[144:147]
  v_cvt_pk_bf16_f32 v234, v32, v33
  v_cvt_pk_bf16_f32 v235, v34, v35
  v_cvt_pk_bf16_f32 v236, v36, v37
  v_cvt_pk_bf16_f32 v237, v38, v39
  v_cvt_pk_bf16_f32 v238, v40, v41
  v_cvt_pk_bf16_f32 v239, v42, v43
  v_cvt_pk_bf16_f32 v240, v44, v45
  v_cvt_pk_bf16_f32 v241, v46, v47
  v_permlane32_swap_b32 v234, v236
  v_permlane32_swap_b32 v235, v237
  v_permlane32_swap_b32 v238, v240
  v_permlane32_swap_b32 v239, v241
  v_permlane16_swap_b32 v234, v236
  v_permlane16_swap_b32 v235, v237
  v_permlane16_swap_b32 v238, v240
  v_permlane16_swap_b32 v239, v241
  v_accvgpr_write_b32 a16, v234
  v_accvgpr_write_b32 a17, v235
  v_accvgpr_write_b32 a18, v236
  v_accvgpr_write_b32 a19, v237
  v_accvgpr_write_b32 a20, v238
  v_accvgpr_write_b32 a21, v239
  v_accvgpr_write_b32 a22, v240
  v_accvgpr_write_b32 a23, v241
  v_pk_mul_f32 v[48:49], v[48:49], s[74:75]
  v_pk_mul_f32 v[50:51], v[50:51], s[74:75]
  v_pk_mul_f32 v[52:53], v[52:53], s[74:75]
  v_pk_mul_f32 v[54:55], v[54:55], s[74:75]
  v_pk_mul_f32 v[56:57], v[56:57], s[74:75]
  v_pk_mul_f32 v[58:59], v[58:59], s[74:75]
  v_pk_mul_f32 v[60:61], v[60:61], s[74:75]
  v_pk_mul_f32 v[62:63], v[62:63], s[74:75]
  v_cvt_pk_bf16_f32 v234, v48, v49
  v_cvt_pk_bf16_f32 v235, v50, v51
  v_cvt_pk_bf16_f32 v236, v52, v53
  v_cvt_pk_bf16_f32 v237, v54, v55
  v_cvt_pk_bf16_f32 v238, v56, v57
  v_cvt_pk_bf16_f32 v239, v58, v59
  v_cvt_pk_bf16_f32 v240, v60, v61
  v_cvt_pk_bf16_f32 v241, v62, v63
  v_permlane32_swap_b32 v234, v236
  v_permlane32_swap_b32 v235, v237
  v_permlane32_swap_b32 v238, v240
  v_permlane32_swap_b32 v239, v241
  v_permlane16_swap_b32 v234, v236
  v_permlane16_swap_b32 v235, v237
  v_permlane16_swap_b32 v238, v240
  v_permlane16_swap_b32 v239, v241
  v_accvgpr_write_b32 a24, v234
  v_accvgpr_write_b32 a25, v235
  v_accvgpr_write_b32 a26, v236
  v_accvgpr_write_b32 a27, v237
  v_accvgpr_write_b32 a28, v238
  v_accvgpr_write_b32 a29, v239
  v_accvgpr_write_b32 a30, v240
  v_accvgpr_write_b32 a31, v241
  v_pk_mul_f32 v[64:65], v[64:65], s[74:75]
  v_pk_mul_f32 v[66:67], v[66:67], s[74:75]
  v_mfma_f32_16x16x32_bf16 v[148:151], a[64:67], a[16:19], 0
  v_pk_mul_f32 v[68:69], v[68:69], s[74:75]
  v_pk_mul_f32 v[70:71], v[70:71], s[74:75]
  v_mfma_f32_16x16x32_bf16 v[148:151], a[68:71], a[20:23], v[148:151]
  v_pk_mul_f32 v[72:73], v[72:73], s[74:75]
  v_pk_mul_f32 v[74:75], v[74:75], s[74:75]
  v_mfma_f32_16x16x32_bf16 v[148:151], a[72:75], a[24:27], v[148:151]
  v_pk_mul_f32 v[76:77], v[76:77], s[74:75]
  v_pk_mul_f32 v[78:79], v[78:79], s[74:75]
  v_mfma_f32_16x16x32_bf16 v[148:151], a[76:79], a[28:31], v[148:151]
  v_cvt_pk_bf16_f32 v234, v64, v65
  v_cvt_pk_bf16_f32 v235, v66, v67
  v_cvt_pk_bf16_f32 v236, v68, v69
  v_cvt_pk_bf16_f32 v237, v70, v71
  v_cvt_pk_bf16_f32 v238, v72, v73
  v_cvt_pk_bf16_f32 v239, v74, v75
  v_cvt_pk_bf16_f32 v240, v76, v77
  v_cvt_pk_bf16_f32 v241, v78, v79
  v_permlane32_swap_b32 v234, v236
  v_permlane32_swap_b32 v235, v237
  v_permlane32_swap_b32 v238, v240
  v_permlane32_swap_b32 v239, v241
  v_permlane16_swap_b32 v234, v236
  v_permlane16_swap_b32 v235, v237
  v_permlane16_swap_b32 v238, v240
  v_permlane16_swap_b32 v239, v241
  v_accvgpr_write_b32 a32, v234
  v_accvgpr_write_b32 a33, v235
  v_accvgpr_write_b32 a34, v236
  v_accvgpr_write_b32 a35, v237
  v_accvgpr_write_b32 a36, v238
  v_accvgpr_write_b32 a37, v239
  v_accvgpr_write_b32 a38, v240
  v_accvgpr_write_b32 a39, v241
  v_pk_mul_f32 v[80:81], v[80:81], s[74:75]
  v_pk_mul_f32 v[82:83], v[82:83], s[74:75]
  v_pk_mul_f32 v[84:85], v[84:85], s[74:75]
  v_pk_mul_f32 v[86:87], v[86:87], s[74:75]
  v_pk_mul_f32 v[88:89], v[88:89], s[74:75]
  v_pk_mul_f32 v[90:91], v[90:91], s[74:75]
  v_pk_mul_f32 v[92:93], v[92:93], s[74:75]
  v_pk_mul_f32 v[94:95], v[94:95], s[74:75]
  v_cvt_pk_bf16_f32 v234, v80, v81
  v_cvt_pk_bf16_f32 v235, v82, v83
  v_cvt_pk_bf16_f32 v236, v84, v85
  v_cvt_pk_bf16_f32 v237, v86, v87
  v_cvt_pk_bf16_f32 v238, v88, v89
  v_cvt_pk_bf16_f32 v239, v90, v91
  v_cvt_pk_bf16_f32 v240, v92, v93
  v_cvt_pk_bf16_f32 v241, v94, v95
  v_permlane32_swap_b32 v234, v236
  v_permlane32_swap_b32 v235, v237
  v_permlane32_swap_b32 v238, v240
  v_permlane32_swap_b32 v239, v241
  v_permlane16_swap_b32 v234, v236
  v_permlane16_swap_b32 v235, v237
  v_permlane16_swap_b32 v238, v240
  v_permlane16_swap_b32 v239, v241
  v_accvgpr_write_b32 a40, v234
  v_accvgpr_write_b32 a41, v235
  v_accvgpr_write_b32 a42, v236
  v_accvgpr_write_b32 a43, v237
  v_accvgpr_write_b32 a44, v238
  v_accvgpr_write_b32 a45, v239
  v_accvgpr_write_b32 a46, v240
  v_accvgpr_write_b32 a47, v241
  v_pk_mul_f32 v[96:97], v[96:97], s[74:75]
  v_pk_mul_f32 v[98:99], v[98:99], s[74:75]
  v_mfma_f32_16x16x32_bf16 v[152:155], a[64:67], a[32:35], 0
  v_pk_mul_f32 v[100:101], v[100:101], s[74:75]
  v_pk_mul_f32 v[102:103], v[102:103], s[74:75]
  v_mfma_f32_16x16x32_bf16 v[152:155], a[68:71], a[36:39], v[152:155]
  v_pk_mul_f32 v[104:105], v[104:105], s[74:75]
  v_pk_mul_f32 v[106:107], v[106:107], s[74:75]
  v_mfma_f32_16x16x32_bf16 v[152:155], a[72:75], a[40:43], v[152:155]
  v_pk_mul_f32 v[108:109], v[108:109], s[74:75]
  v_pk_mul_f32 v[110:111], v[110:111], s[74:75]
  v_mfma_f32_16x16x32_bf16 v[152:155], a[76:79], a[44:47], v[152:155]
  v_cvt_pk_bf16_f32 v234, v96, v97
  v_cvt_pk_bf16_f32 v235, v98, v99
  v_cvt_pk_bf16_f32 v236, v100, v101
  v_cvt_pk_bf16_f32 v237, v102, v103
  v_cvt_pk_bf16_f32 v238, v104, v105
  v_cvt_pk_bf16_f32 v239, v106, v107
  v_cvt_pk_bf16_f32 v240, v108, v109
  v_cvt_pk_bf16_f32 v241, v110, v111
  v_permlane32_swap_b32 v234, v236
  v_permlane32_swap_b32 v235, v237
  v_permlane32_swap_b32 v238, v240
  v_permlane32_swap_b32 v239, v241
  v_permlane16_swap_b32 v234, v236
  v_permlane16_swap_b32 v235, v237
  v_permlane16_swap_b32 v238, v240
  v_permlane16_swap_b32 v239, v241
  v_accvgpr_write_b32 a48, v234
  v_accvgpr_write_b32 a49, v235
  v_accvgpr_write_b32 a50, v236
  v_accvgpr_write_b32 a51, v237
  v_accvgpr_write_b32 a52, v238
  v_accvgpr_write_b32 a53, v239
  v_accvgpr_write_b32 a54, v240
  v_accvgpr_write_b32 a55, v241
  v_pk_mul_f32 v[112:113], v[112:113], s[74:75]
  v_pk_mul_f32 v[114:115], v[114:115], s[74:75]
  v_pk_mul_f32 v[116:117], v[116:117], s[74:75]
  v_pk_mul_f32 v[118:119], v[118:119], s[74:75]
  v_pk_mul_f32 v[120:121], v[120:121], s[74:75]
  v_pk_mul_f32 v[122:123], v[122:123], s[74:75]
  v_pk_mul_f32 v[124:125], v[124:125], s[74:75]
  v_pk_mul_f32 v[126:127], v[126:127], s[74:75]
  v_cvt_pk_bf16_f32 v234, v112, v113
  v_cvt_pk_bf16_f32 v235, v114, v115
  v_cvt_pk_bf16_f32 v236, v116, v117
  v_cvt_pk_bf16_f32 v237, v118, v119
  v_cvt_pk_bf16_f32 v238, v120, v121
  v_cvt_pk_bf16_f32 v239, v122, v123
  v_cvt_pk_bf16_f32 v240, v124, v125
  v_cvt_pk_bf16_f32 v241, v126, v127
  v_permlane32_swap_b32 v234, v236
  v_permlane32_swap_b32 v235, v237
  v_permlane32_swap_b32 v238, v240
  v_permlane32_swap_b32 v239, v241
  v_permlane16_swap_b32 v234, v236
  v_permlane16_swap_b32 v235, v237
  v_permlane16_swap_b32 v238, v240
  v_permlane16_swap_b32 v239, v241
  v_accvgpr_write_b32 a56, v234
  v_accvgpr_write_b32 a57, v235
  v_accvgpr_write_b32 a58, v236
  v_accvgpr_write_b32 a59, v237
  v_accvgpr_write_b32 a60, v238
  v_accvgpr_write_b32 a61, v239
  v_accvgpr_write_b32 a62, v240
  v_accvgpr_write_b32 a63, v241
  s_nop 1
  v_mfma_f32_16x16x32_bf16 v[156:159], a[64:67], a[48:51], 0
  v_mfma_f32_16x16x32_bf16 v[156:159], a[68:71], a[52:55], v[156:159]
  v_mfma_f32_16x16x32_bf16 v[156:159], a[72:75], a[56:59], v[156:159]
  v_mfma_f32_16x16x32_bf16 v[156:159], a[76:79], a[60:63], v[156:159]
  s_nop 7
  v_max3_f32 v234, v144, v145, v146
  v_max_f32 v234, v234, v147
  v_mov_b32 v235, v234
  v_max3_f32 v236, v148, v149, v150
  v_max_f32 v236, v236, v151
  v_mov_b32 v237, v236
  v_max3_f32 v238, v152, v153, v154
  v_max_f32 v238, v238, v155
  v_mov_b32 v239, v238
  v_max3_f32 v240, v156, v157, v158
  v_max_f32 v240, v240, v159
  v_mov_b32 v241, v240
  s_nop 0
  v_permlane32_swap_b32 v234, v235
  v_permlane32_swap_b32 v236, v237
  v_permlane32_swap_b32 v238, v239
  v_permlane32_swap_b32 v240, v241
  v_max_f32 v234, v234, v235
  v_max_f32 v236, v236, v237
  v_max_f32 v238, v238, v239
  v_max_f32 v240, v240, v241
  v_mov_b32 v235, v234
  v_mov_b32 v237, v236
  v_mov_b32 v239, v238
  v_mov_b32 v241, v240
  s_nop 0
  v_permlane16_swap_b32 v234, v235
  v_permlane16_swap_b32 v236, v237
  v_permlane16_swap_b32 v238, v239
  v_permlane16_swap_b32 v240, v241
  v_max_f32 v234, v234, v235
  v_max_f32 v236, v236, v237
  v_max_f32 v238, v238, v239
  v_max_f32 v240, v240, v241
  v_sub_f32 v168, 0, v234
  v_sub_f32 v169, 0, v234
  v_sub_f32 v170, 0, v234
  v_sub_f32 v171, 0, v234
  v_sub_f32 v172, 0, v236
  v_sub_f32 v173, 0, v236
  v_sub_f32 v174, 0, v236
  v_sub_f32 v175, 0, v236
  v_sub_f32 v176, 0, v238
  v_sub_f32 v177, 0, v238
  v_sub_f32 v178, 0, v238
  v_sub_f32 v179, 0, v238
  v_sub_f32 v180, 0, v240
  v_sub_f32 v181, 0, v240
  v_sub_f32 v182, 0, v240
  v_sub_f32 v183, 0, v240
  s_nop 1
L_att_units:
  s_waitcnt vmcnt(9) lgkmcnt(0)
  s_barrier
  v_mfma_f32_16x16x32_bf16 v[144:147], a[64:67], a[0:3], v[168:171]
  s_add_u32 m0, s68, 0
  v_mfma_f32_16x16x32_bf16 v[144:147], a[68:71], a[4:7], v[144:147]
  buffer_load_dwordx4 v196, s[28:31], s67 offen offset:0 nt lds
  v_mfma_f32_16x16x32_bf16 v[144:147], a[72:75], a[8:11], v[144:147]
  buffer_load_dwordx4 v197, s[28:31], s67 offen offset:1024 nt lds
  v_mfma_f32_16x16x32_bf16 v[144:147], a[76:79], a[12:15], v[144:147]
  s_add_u32 m0, s68, 8192
  v_mfma_f32_16x16x32_bf16 v[148:151], a[80:83], a[0:3], v[168:171]
  buffer_load_dwordx4 v196, s[32:35], s69 offen offset:0 nt lds
  v_mfma_f32_16x16x32_bf16 v[148:151], a[84:87], a[4:7], v[148:151]
  buffer_load_dwordx4 v197, s[32:35], s69 offen offset:1024 nt lds
  v_mfma_f32_16x16x32_bf16 v[148:151], a[88:91], a[8:11], v[148:151]
  v_mfma_f32_16x16x32_bf16 v[148:151], a[92:95], a[12:15], v[148:151]
  s_mov_b32 s69, s67
  s_add_u32 s67, s67, 8192
  ds_read_b64_tr_b16 a[96:97], v188 offset:24576
  ds_read_b64_tr_b16 a[98:99], v188 offset:28672
  ds_read_b64_tr_b16 a[100:101], v189 offset:24576
  ds_read_b64_tr_b16 a[102:103], v189 offset:28672
  ds_read_b64_tr_b16 a[104:105], v190 offset:24576
  ds_read_b64_tr_b16 a[106:107], v190 offset:28672
  ds_read_b64_tr_b16 a[108:109], v191 offset:24576
  ds_read_b64_tr_b16 a[110:111], v191 offset:28672
  ds_read_b64_tr_b16 a[112:113], v192 offset:24576
  ds_read_b64_tr_b16 a[114:115], v192 offset:28672
  ds_read_b64_tr_b16 a[116:117], v193 offset:24576
  ds_read_b64_tr_b16 a[118:119], v193 offset:28672
  ds_read_b64_tr_b16 a[120:121], v194 offset:24576
  ds_read_b64_tr_b16 a[122:123], v194 offset:28672
  ds_read_b64_tr_b16 a[124:125], v195 offset:24576
  ds_read_b64_tr_b16 a[126:127], v195 offset:28672
  v_mfma_f32_16x16x32_bf16 v[152:155], a[64:67], a[16:19], v[172:175]
  v_exp_f32 v144, v144
  v_mfma_f32_16x16x32_bf16 v[152:155], a[68:71], a[20:23], v[152:155]
  v_exp_f32 v145, v145
  v_mfma_f32_16x16x32_bf16 v[152:155], a[72:75], a[24:27], v[152:155]
  v_exp_f32 v146, v146
  v_mfma_f32_16x16x32_bf16 v[152:155], a[76:79], a[28:31], v[152:155]
  v_exp_f32 v147, v147
  v_cvt_pk_bf16_f32 v160, v144, v145
  v_mfma_f32_16x16x32_bf16 v[156:159], a[80:83], a[16:19], v[172:175]
  v_exp_f32 v148, v148
  v_mfma_f32_16x16x32_bf16 v[156:159], a[84:87], a[20:23], v[156:159]
  v_exp_f32 v149, v149
  v_cvt_pk_bf16_f32 v161, v146, v147
  v_mfma_f32_16x16x32_bf16 v[156:159], a[88:91], a[24:27], v[156:159]
  v_exp_f32 v150, v150
  v_exp_f32 v151, v151
  v_mfma_f32_16x16x32_bf16 v[156:159], a[92:95], a[28:31], v[156:159]
  v_cvt_pk_bf16_f32 v162, v148, v149
  v_cvt_pk_bf16_f32 v163, v150, v151
  s_waitcnt lgkmcnt(0)
  v_mfma_f32_16x16x32_bf16 v[144:147], a[64:67], a[32:35], v[176:179]
  v_exp_f32 v152, v152
  v_mfma_f32_16x16x32_bf16 v[144:147], a[68:71], a[36:39], v[144:147]
  v_mfma_f32_16x16x32_bf16 v[144:147], a[72:75], a[40:43], v[144:147]
  v_exp_f32 v153, v153
  v_mfma_f32_16x16x32_bf16 v[144:147], a[76:79], a[44:47], v[144:147]
  v_cvt_pk_bf16_f32 v164, v152, v153
  v_mfma_f32_16x16x32_bf16 v[148:151], a[80:83], a[32:35], v[176:179]
  v_exp_f32 v154, v154
  v_mfma_f32_16x16x32_bf16 v[148:151], a[84:87], a[36:39], v[148:151]
  v_mfma_f32_16x16x32_bf16 v[148:151], a[88:91], a[40:43], v[148:151]
  v_exp_f32 v155, v155
  v_mfma_f32_16x16x32_bf16 v[148:151], a[92:95], a[44:47], v[148:151]
  v_cvt_pk_bf16_f32 v165, v154, v155
  v_mfma_f32_16x16x32_bf16 v[0:3], a[96:99], v[160:163], 0
  v_exp_f32 v156, v156
  v_mfma_f32_16x16x32_bf16 v[4:7], a[100:103], v[160:163], 0
  v_mfma_f32_16x16x32_bf16 v[8:11], a[104:107], v[160:163], 0
  v_exp_f32 v157, v157
  v_mfma_f32_16x16x32_bf16 v[12:15], a[108:111], v[160:163], 0
  v_cvt_pk_bf16_f32 v166, v156, v157
  v_mfma_f32_16x16x32_bf16 v[16:19], a[112:115], v[160:163], 0
  v_exp_f32 v158, v158
  v_mfma_f32_16x16x32_bf16 v[20:23], a[116:119], v[160:163], 0
  v_mfma_f32_16x16x32_bf16 v[24:27], a[120:123], v[160:163], 0
  v_exp_f32 v159, v159
  v_mfma_f32_16x16x32_bf16 v[28:31], a[124:127], v[160:163], 0
  v_cvt_pk_bf16_f32 v167, v158, v159
  v_mfma_f32_16x16x32_bf16 v[128:131], a[228:231], v[160:163], 0
  v_mfma_f32_16x16x32_bf16 v[152:155], a[64:67], a[48:51], v[180:183]
  v_exp_f32 v144, v144
  v_mfma_f32_16x16x32_bf16 v[152:155], a[68:71], a[52:55], v[152:155]
  ds_read_b128 a[64:67], v184 offset:16384
  ds_read_b128 a[68:71], v185 offset:16384
  v_mfma_f32_16x16x32_bf16 v[152:155], a[72:75], a[56:59], v[152:155]
  v_exp_f32 v145, v145
  v_mfma_f32_16x16x32_bf16 v[152:155], a[76:79], a[60:63], v[152:155]
  ds_read_b128 a[72:75], v186 offset:16384
  ds_read_b128 a[76:79], v187 offset:16384
  v_cvt_pk_bf16_f32 v160, v144, v145
  v_mfma_f32_16x16x32_bf16 v[156:159], a[80:83], a[48:51], v[180:183]
  v_exp_f32 v146, v146
  v_mfma_f32_16x16x32_bf16 v[156:159], a[84:87], a[52:55], v[156:159]
  ds_read_b128 a[80:83], v184 offset:20480
  ds_read_b128 a[84:87], v185 offset:20480
  v_mfma_f32_16x16x32_bf16 v[156:159], a[88:91], a[56:59], v[156:159]
  v_exp_f32 v147, v147
  v_mfma_f32_16x16x32_bf16 v[156:159], a[92:95], a[60:63], v[156:159]
  ds_read_b128 a[88:91], v186 offset:20480
  v_cvt_pk_bf16_f32 v161, v146, v147
  v_mfma_f32_16x16x32_bf16 v[32:35], a[96:99], v[164:167], 0
  v_exp_f32 v148, v148
  v_mfma_f32_16x16x32_bf16 v[36:39], a[100:103], v[164:167], 0
  ds_read_b128 a[92:95], v187 offset:20480
  v_mfma_f32_16x16x32_bf16 v[40:43], a[104:107], v[164:167], 0
  v_exp_f32 v149, v149
  v_mfma_f32_16x16x32_bf16 v[44:47], a[108:111], v[164:167], 0
  v_cvt_pk_bf16_f32 v162, v148, v149
  v_mfma_f32_16x16x32_bf16 v[48:51], a[112:115], v[164:167], 0
  v_exp_f32 v150, v150
  v_mfma_f32_16x16x32_bf16 v[52:55], a[116:119], v[164:167], 0
  v_mfma_f32_16x16x32_bf16 v[56:59], a[120:123], v[164:167], 0
  v_exp_f32 v151, v151
  v_mfma_f32_16x16x32_bf16 v[60:63], a[124:127], v[164:167], 0
  v_cvt_pk_bf16_f32 v163, v150, v151
  v_mfma_f32_16x16x32_bf16 v[132:135], a[228:231], v[164:167], 0
  s_waitcnt vmcnt(9) lgkmcnt(0)
  s_barrier
  v_mfma_f32_16x16x32_bf16 v[144:147], a[64:67], a[0:3], v[168:171]
  s_add_u32 m0, s68, 16384
  v_exp_f32 v152, v152
  v_mfma_f32_16x16x32_bf16 v[144:147], a[68:71], a[4:7], v[144:147]
  buffer_load_dwordx4 v196, s[28:31], s67 offen offset:0 nt lds
  v_mfma_f32_16x16x32_bf16 v[144:147], a[72:75], a[8:11], v[144:147]
  v_exp_f32 v153, v153
  v_mfma_f32_16x16x32_bf16 v[144:147], a[76:79], a[12:15], v[144:147]
  v_cvt_pk_bf16_f32 v164, v152, v153
  v_mfma_f32_16x16x32_bf16 v[148:151], a[80:83], a[0:3], v[168:171]
  v_exp_f32 v154, v154
  v_mfma_f32_16x16x32_bf16 v[148:151], a[84:87], a[4:7], v[148:151]
  buffer_load_dwordx4 v197, s[28:31], s67 offen offset:1024 nt lds
  v_mfma_f32_16x16x32_bf16 v[148:151], a[88:91], a[8:11], v[148:151]
  v_exp_f32 v155, v155
  v_mfma_f32_16x16x32_bf16 v[148:151], a[92:95], a[12:15], v[148:151]
  v_cvt_pk_bf16_f32 v165, v154, v155
  v_mfma_f32_16x16x32_bf16 v[64:67], a[96:99], v[160:163], 0
  s_add_u32 m0, s68, 24576
  v_exp_f32 v156, v156
  v_mfma_f32_16x16x32_bf16 v[68:71], a[100:103], v[160:163], 0
  buffer_load_dwordx4 v196, s[32:35], s69 offen offset:0 nt lds
  v_mfma_f32_16x16x32_bf16 v[72:75], a[104:107], v[160:163], 0
  v_exp_f32 v157, v157
  v_mfma_f32_16x16x32_bf16 v[76:79], a[108:111], v[160:163], 0
  v_cvt_pk_bf16_f32 v166, v156, v157
  v_mfma_f32_16x16x32_bf16 v[80:83], a[112:115], v[160:163], 0
  v_exp_f32 v158, v158
  v_mfma_f32_16x16x32_bf16 v[84:87], a[116:119], v[160:163], 0
  buffer_load_dwordx4 v197, s[32:35], s69 offen offset:1024 nt lds
  v_mfma_f32_16x16x32_bf16 v[88:91], a[120:123], v[160:163], 0
  v_exp_f32 v159, v159
  v_mfma_f32_16x16x32_bf16 v[92:95], a[124:127], v[160:163], 0
  v_cvt_pk_bf16_f32 v167, v158, v159
  v_mfma_f32_16x16x32_bf16 v[136:139], a[228:231], v[160:163], 0
  s_mov_b32 s69, s67
  s_add_u32 s67, s67, 8192
  v_mfma_f32_16x16x32_bf16 v[152:155], a[64:67], a[16:19], v[172:175]
  v_exp_f32 v144, v144
  v_mfma_f32_16x16x32_bf16 v[152:155], a[68:71], a[20:23], v[152:155]
  v_mfma_f32_16x16x32_bf16 v[152:155], a[72:75], a[24:27], v[152:155]
  v_exp_f32 v145, v145
  v_mfma_f32_16x16x32_bf16 v[152:155], a[76:79], a[28:31], v[152:155]
  v_cvt_pk_bf16_f32 v160, v144, v145
  v_mfma_f32_16x16x32_bf16 v[156:159], a[80:83], a[16:19], v[172:175]
  v_exp_f32 v146, v146
  v_mfma_f32_16x16x32_bf16 v[156:159], a[84:87], a[20:23], v[156:159]
  v_mfma_f32_16x16x32_bf16 v[156:159], a[88:91], a[24:27], v[156:159]
  v_exp_f32 v147, v147
  v_mfma_f32_16x16x32_bf16 v[156:159], a[92:95], a[28:31], v[156:159]
  v_cvt_pk_bf16_f32 v161, v146, v147
  v_mfma_f32_16x16x32_bf16 v[96:99], a[96:99], v[164:167], 0
  v_exp_f32 v148, v148
  v_mfma_f32_16x16x32_bf16 v[100:103], a[100:103], v[164:167], 0
  ds_read_b64_tr_b16 a[96:97], v188 offset:40960
  ds_read_b64_tr_b16 a[98:99], v188 offset:45056
  v_mfma_f32_16x16x32_bf16 v[104:107], a[104:107], v[164:167], 0
  v_exp_f32 v149, v149
  v_mfma_f32_16x16x32_bf16 v[108:111], a[108:111], v[164:167], 0
  ds_read_b64_tr_b16 a[100:101], v189 offset:40960
  ds_read_b64_tr_b16 a[102:103], v189 offset:45056
  v_cvt_pk_bf16_f32 v162, v148, v149
  v_mfma_f32_16x16x32_bf16 v[112:115], a[112:115], v[164:167], 0
  v_exp_f32 v150, v150
  v_mfma_f32_16x16x32_bf16 v[116:119], a[116:119], v[164:167], 0
  ds_read_b64_tr_b16 a[104:105], v190 offset:40960
  ds_read_b64_tr_b16 a[106:107], v190 offset:45056
  v_mfma_f32_16x16x32_bf16 v[120:123], a[120:123], v[164:167], 0
  v_exp_f32 v151, v151
  v_mfma_f32_16x16x32_bf16 v[124:127], a[124:127], v[164:167], 0
  ds_read_b64_tr_b16 a[108:109], v191 offset:40960
  v_cvt_pk_bf16_f32 v163, v150, v151
  v_mfma_f32_16x16x32_bf16 v[140:143], a[228:231], v[164:167], 0
  ds_read_b64_tr_b16 a[110:111], v191 offset:45056
  ds_read_b64_tr_b16 a[112:113], v192 offset:40960
  s_mov_b32 s64, 7
.p2align 4
L_att:
  v_mfma_f32_16x16x32_bf16 v[144:147], a[64:67], a[32:35], v[176:179]
  v_exp_f32 v152, v152
  v_mfma_f32_16x16x32_bf16 v[144:147], a[68:71], a[36:39], v[144:147]
  ds_read_b64_tr_b16 a[114:115], v192 offset:45056
  ds_read_b64_tr_b16 a[116:117], v193 offset:40960
  v_mfma_f32_16x16x32_bf16 v[144:147], a[72:75], a[40:43], v[144:147]
  v_exp_f32 v153, v153
  v_mfma_f32_16x16x32_bf16 v[144:147], a[76:79], a[44:47], v[144:147]
  ds_read_b64_tr_b16 a[118:119], v193 offset:45056
  ds_read_b64_tr_b16 a[120:121], v194 offset:40960
  v_cvt_pk_bf16_f32 v164, v152, v153
  v_mfma_f32_16x16x32_bf16 v[148:151], a[80:83], a[32:35], v[176:179]
  v_exp_f32 v154, v154
  v_mfma_f32_16x16x32_bf16 v[148:151], a[84:87], a[36:39], v[148:151]
  ds_read_b64_tr_b16 a[122:123], v194 offset:45056
  ds_read_b64_tr_b16 a[124:125], v195 offset:40960
  v_mfma_f32_16x16x32_bf16 v[148:151], a[88:91], a[40:43], v[148:151]
  v_exp_f32 v155, v155
  v_mfma_f32_16x16x32_bf16 v[148:151], a[92:95], a[44:47], v[148:151]
  ds_read_b64_tr_b16 a[126:127], v195 offset:45056
  v_cvt_pk_bf16_f32 v165, v154, v155
  s_waitcnt lgkmcnt(3)
  v_mfma_f32_16x16x32_bf16 v[0:3], a[96:99], v[160:163], v[0:3]
  v_exp_f32 v156, v156
  v_mfma_f32_16x16x32_bf16 v[4:7], a[100:103], v[160:163], v[4:7]
  v_mfma_f32_16x16x32_bf16 v[8:11], a[104:107], v[160:163], v[8:11]
  v_exp_f32 v157, v157
  v_mfma_f32_16x16x32_bf16 v[12:15], a[108:111], v[160:163], v[12:15]
  v_cvt_pk_bf16_f32 v166, v156, v157
  v_mfma_f32_16x16x32_bf16 v[16:19], a[112:115], v[160:163], v[16:19]
  v_exp_f32 v158, v158
  v_mfma_f32_16x16x32_bf16 v[20:23], a[116:119], v[160:163], v[20:23]
  s_waitcnt lgkmcnt(0)
  v_mfma_f32_16x16x32_bf16 v[24:27], a[120:123], v[160:163], v[24:27]
  v_exp_f32 v159, v159
  v_mfma_f32_16x16x32_bf16 v[28:31], a[124:127], v[160:163], v[28:31]
  v_cvt_pk_bf16_f32 v167, v158, v159
  v_mfma_f32_16x16x32_bf16 v[128:131], a[228:231], v[160:163], v[128:131]
  v_mfma_f32_16x16x32_bf16 v[152:155], a[64:67], a[48:51], v[180:183]
  v_exp_f32 v144, v144
  v_mfma_f32_16x16x32_bf16 v[152:155], a[68:71], a[52:55], v[152:155]
  ds_read_b128 a[64:67], v184 offset:32768
  ds_read_b128 a[68:71], v185 offset:32768
  v_mfma_f32_16x16x32_bf16 v[152:155], a[72:75], a[56:59], v[152:155]
  v_exp_f32 v145, v145
  v_mfma_f32_16x16x32_bf16 v[152:155], a[76:79], a[60:63], v[152:155]
  ds_read_b128 a[72:75], v186 offset:32768
  ds_read_b128 a[76:79], v187 offset:32768
  v_cvt_pk_bf16_f32 v160, v144, v145
  v_mfma_f32_16x16x32_bf16 v[156:159], a[80:83], a[48:51], v[180:183]
  v_exp_f32 v146, v146
  v_mfma_f32_16x16x32_bf16 v[156:159], a[84:87], a[52:55], v[156:159]
  ds_read_b128 a[80:83], v184 offset:36864
  ds_read_b128 a[84:87], v185 offset:36864
  v_mfma_f32_16x16x32_bf16 v[156:159], a[88:91], a[56:59], v[156:159]
  v_exp_f32 v147, v147
  v_mfma_f32_16x16x32_bf16 v[156:159], a[92:95], a[60:63], v[156:159]
  ds_read_b128 a[88:91], v186 offset:36864
  v_cvt_pk_bf16_f32 v161, v146, v147
  v_mfma_f32_16x16x32_bf16 v[32:35], a[96:99], v[164:167], v[32:35]
  v_exp_f32 v148, v148
  v_mfma_f32_16x16x32_bf16 v[36:39], a[100:103], v[164:167], v[36:39]
  ds_read_b128 a[92:95], v187 offset:36864
  v_mfma_f32_16x16x32_bf16 v[40:43], a[104:107], v[164:167], v[40:43]
  v_exp_f32 v149, v149
  v_mfma_f32_16x16x32_bf16 v[44:47], a[108:111], v[164:167], v[44:47]
  v_cvt_pk_bf16_f32 v162, v148, v149
  v_mfma_f32_16x16x32_bf16 v[48:51], a[112:115], v[164:167], v[48:51]
  v_exp_f32 v150, v150
  v_mfma_f32_16x16x32_bf16 v[52:55], a[116:119], v[164:167], v[52:55]
  v_mfma_f32_16x16x32_bf16 v[56:59], a[120:123], v[164:167], v[56:59]
  v_exp_f32 v151, v151
  v_mfma_f32_16x16x32_bf16 v[60:63], a[124:127], v[164:167], v[60:63]
  v_cvt_pk_bf16_f32 v163, v150, v151
  v_mfma_f32_16x16x32_bf16 v[132:135], a[228:231], v[164:167], v[132:135]
  s_waitcnt vmcnt(8) lgkmcnt(0)
  s_barrier
  v_mfma_f32_16x16x32_bf16 v[144:147], a[64:67], a[0:3], v[168:171]
  s_add_u32 m0, s68, 32768
  v_exp_f32 v152, v152
  v_mfma_f32_16x16x32_bf16 v[144:147], a[68:71], a[4:7], v[144:147]
  buffer_load_dwordx4 v196, s[28:31], s67 offen offset:0 nt lds
  v_mfma_f32_16x16x32_bf16 v[144:147], a[72:75], a[8:11], v[144:147]
  v_exp_f32 v153, v153
  v_mfma_f32_16x16x32_bf16 v[144:147], a[76:79], a[12:15], v[144:147]
  v_cvt_pk_bf16_f32 v164, v152, v153
  v_mfma_f32_16x16x32_bf16 v[148:151], a[80:83], a[0:3], v[168:171]
  v_exp_f32 v154, v154
  v_mfma_f32_16x16x32_bf16 v[148:151], a[84:87], a[4:7], v[148:151]
  buffer_load_dwordx4 v197, s[28:31], s67 offen offset:1024 nt lds
  v_mfma_f32_16x16x32_bf16 v[148:151], a[88:91], a[8:11], v[148:151]
  v_exp_f32 v155, v155
  v_mfma_f32_16x16x32_bf16 v[148:151], a[92:95], a[12:15], v[148:151]
  v_cvt_pk_bf16_f32 v165, v154, v155
  v_mfma_f32_16x16x32_bf16 v[64:67], a[96:99], v[160:163], v[64:67]
  s_add_u32 m0, s68, 40960
  v_exp_f32 v156, v156
  v_mfma_f32_16x16x32_bf16 v[68:71], a[100:103], v[160:163], v[68:71]
  buffer_load_dwordx4 v196, s[32:35], s69 offen offset:0 nt lds
  v_mfma_f32_16x16x32_bf16 v[72:75], a[104:107], v[160:163], v[72:75]
  v_exp_f32 v157, v157
  v_mfma_f32_16x16x32_bf16 v[76:79], a[108:111], v[160:163], v[76:79]
  v_cvt_pk_bf16_f32 v166, v156, v157
  v_mfma_f32_16x16x32_bf16 v[80:83], a[112:115], v[160:163], v[80:83]
  v_exp_f32 v158, v158
  v_mfma_f32_16x16x32_bf16 v[84:87], a[116:119], v[160:163], v[84:87]
  buffer_load_dwordx4 v197, s[32:35], s69 offen offset:1024 nt lds
  v_mfma_f32_16x16x32_bf16 v[88:91], a[120:123], v[160:163], v[88:91]
  v_exp_f32 v159, v159
  v_mfma_f32_16x16x32_bf16 v[92:95], a[124:127], v[160:163], v[92:95]
  v_cvt_pk_bf16_f32 v167, v158, v159
  v_mfma_f32_16x16x32_bf16 v[136:139], a[228:231], v[160:163], v[136:139]
  s_mov_b32 s69, s67
  s_add_u32 s67, s67, 8192
  v_mfma_f32_16x16x32_bf16 v[152:155], a[64:67], a[16:19], v[172:175]
  v_exp_f32 v144, v144
  v_mfma_f32_16x16x32_bf16 v[152:155], a[68:71], a[20:23], v[152:155]
  v_mfma_f32_16x16x32_bf16 v[152:155], a[72:75], a[24:27], v[152:155]
  v_exp_f32 v145, v145
  v_mfma_f32_16x16x32_bf16 v[152:155], a[76:79], a[28:31], v[152:155]
  v_cvt_pk_bf16_f32 v160, v144, v145
  v_mfma_f32_16x16x32_bf16 v[156:159], a[80:83], a[16:19], v[172:175]
  v_exp_f32 v146, v146
  v_mfma_f32_16x16x32_bf16 v[156:159], a[84:87], a[20:23], v[156:159]
  v_mfma_f32_16x16x32_bf16 v[156:159], a[88:91], a[24:27], v[156:159]
  v_exp_f32 v147, v147
  v_mfma_f32_16x16x32_bf16 v[156:159], a[92:95], a[28:31], v[156:159]
  v_cvt_pk_bf16_f32 v161, v146, v147
  v_mfma_f32_16x16x32_bf16 v[96:99], a[96:99], v[164:167], v[96:99]
  v_exp_f32 v148, v148
  v_mfma_f32_16x16x32_bf16 v[100:103], a[100:103], v[164:167], v[100:103]
  ds_read_b64_tr_b16 a[96:97], v188 offset:57344
  ds_read_b64_tr_b16 a[98:99], v188 offset:61440
  v_mfma_f32_16x16x32_bf16 v[104:107], a[104:107], v[164:167], v[104:107]
  v_exp_f32 v149, v149
  v_mfma_f32_16x16x32_bf16 v[108:111], a[108:111], v[164:167], v[108:111]
  ds_read_b64_tr_b16 a[100:101], v189 offset:57344
  ds_read_b64_tr_b16 a[102:103], v189 offset:61440
  v_cvt_pk_bf16_f32 v162, v148, v149
  v_mfma_f32_16x16x32_bf16 v[112:115], a[112:115], v[164:167], v[112:115]
  v_exp_f32 v150, v150
  v_mfma_f32_16x16x32_bf16 v[116:119], a[116:119], v[164:167], v[116:119]
  ds_read_b64_tr_b16 a[104:105], v190 offset:57344
  ds_read_b64_tr_b16 a[106:107], v190 offset:61440
  v_mfma_f32_16x16x32_bf16 v[120:123], a[120:123], v[164:167], v[120:123]
  v_exp_f32 v151, v151
  v_mfma_f32_16x16x32_bf16 v[124:127], a[124:127], v[164:167], v[124:127]
  ds_read_b64_tr_b16 a[108:109], v191 offset:57344
  v_cvt_pk_bf16_f32 v163, v150, v151
  v_mfma_f32_16x16x32_bf16 v[140:143], a[228:231], v[164:167], v[140:143]
  ds_read_b64_tr_b16 a[110:111], v191 offset:61440
  ds_read_b64_tr_b16 a[112:113], v192 offset:57344
  v_mfma_f32_16x16x32_bf16 v[144:147], a[64:67], a[32:35], v[176:179]
  v_exp_f32 v152, v152
  v_mfma_f32_16x16x32_bf16 v[144:147], a[68:71], a[36:39], v[144:147]
  ds_read_b64_tr_b16 a[114:115], v192 offset:61440
  ds_read_b64_tr_b16 a[116:117], v193 offset:57344
  v_mfma_f32_16x16x32_bf16 v[144:147], a[72:75], a[40:43], v[144:147]
  v_exp_f32 v153, v153
  v_mfma_f32_16x16x32_bf16 v[144:147], a[76:79], a[44:47], v[144:147]
  ds_read_b64_tr_b16 a[118:119], v193 offset:61440
  ds_read_b64_tr_b16 a[120:121], v194 offset:57344
  v_cvt_pk_bf16_f32 v164, v152, v153
  v_mfma_f32_16x16x32_bf16 v[148:151], a[80:83], a[32:35], v[176:179]
  v_exp_f32 v154, v154
  v_mfma_f32_16x16x32_bf16 v[148:151], a[84:87], a[36:39], v[148:151]
  ds_read_b64_tr_b16 a[122:123], v194 offset:61440
  ds_read_b64_tr_b16 a[124:125], v195 offset:57344
  v_mfma_f32_16x16x32_bf16 v[148:151], a[88:91], a[40:43], v[148:151]
  v_exp_f32 v155, v155
  v_mfma_f32_16x16x32_bf16 v[148:151], a[92:95], a[44:47], v[148:151]
  ds_read_b64_tr_b16 a[126:127], v195 offset:61440
  v_cvt_pk_bf16_f32 v165, v154, v155
  s_waitcnt lgkmcnt(3)
  v_mfma_f32_16x16x32_bf16 v[0:3], a[96:99], v[160:163], v[0:3]
  v_exp_f32 v156, v156
  v_mfma_f32_16x16x32_bf16 v[4:7], a[100:103], v[160:163], v[4:7]
  v_mfma_f32_16x16x32_bf16 v[8:11], a[104:107], v[160:163], v[8:11]
  v_exp_f32 v157, v157
  v_mfma_f32_16x16x32_bf16 v[12:15], a[108:111], v[160:163], v[12:15]
  v_cvt_pk_bf16_f32 v166, v156, v157
  v_mfma_f32_16x16x32_bf16 v[16:19], a[112:115], v[160:163], v[16:19]
  v_exp_f32 v158, v158
  v_mfma_f32_16x16x32_bf16 v[20:23], a[116:119], v[160:163], v[20:23]
  s_waitcnt lgkmcnt(0)
  v_mfma_f32_16x16x32_bf16 v[24:27], a[120:123], v[160:163], v[24:27]
  v_exp_f32 v159, v159
  v_mfma_f32_16x16x32_bf16 v[28:31], a[124:127], v[160:163], v[28:31]
  v_cvt_pk_bf16_f32 v167, v158, v159
  v_mfma_f32_16x16x32_bf16 v[128:131], a[228:231], v[160:163], v[128:131]
  v_mfma_f32_16x16x32_bf16 v[152:155], a[64:67], a[48:51], v[180:183]
  v_exp_f32 v144, v144
  v_mfma_f32_16x16x32_bf16 v[152:155], a[68:71], a[52:55], v[152:155]
  ds_read_b128 a[64:67], v184 offset:49152
  ds_read_b128 a[68:71], v185 offset:49152
  v_mfma_f32_16x16x32_bf16 v[152:155], a[72:75], a[56:59], v[152:155]
  v_exp_f32 v145, v145
  v_mfma_f32_16x16x32_bf16 v[152:155], a[76:79], a[60:63], v[152:155]
  ds_read_b128 a[72:75], v186 offset:49152
  ds_read_b128 a[76:79], v187 offset:49152
  v_cvt_pk_bf16_f32 v160, v144, v145
  v_mfma_f32_16x16x32_bf16 v[156:159], a[80:83], a[48:51], v[180:183]
  v_exp_f32 v146, v146
  v_mfma_f32_16x16x32_bf16 v[156:159], a[84:87], a[52:55], v[156:159]
  ds_read_b128 a[80:83], v184 offset:53248
  ds_read_b128 a[84:87], v185 offset:53248
  v_mfma_f32_16x16x32_bf16 v[156:159], a[88:91], a[56:59], v[156:159]
  v_exp_f32 v147, v147
  v_mfma_f32_16x16x32_bf16 v[156:159], a[92:95], a[60:63], v[156:159]
  ds_read_b128 a[88:91], v186 offset:53248
  v_cvt_pk_bf16_f32 v161, v146, v147
  v_mfma_f32_16x16x32_bf16 v[32:35], a[96:99], v[164:167], v[32:35]
  v_exp_f32 v148, v148
  v_mfma_f32_16x16x32_bf16 v[36:39], a[100:103], v[164:167], v[36:39]
  ds_read_b128 a[92:95], v187 offset:53248
  v_mfma_f32_16x16x32_bf16 v[40:43], a[104:107], v[164:167], v[40:43]
  v_exp_f32 v149, v149
  v_mfma_f32_16x16x32_bf16 v[44:47], a[108:111], v[164:167], v[44:47]
  v_cvt_pk_bf16_f32 v162, v148, v149
  v_mfma_f32_16x16x32_bf16 v[48:51], a[112:115], v[164:167], v[48:51]
  v_exp_f32 v150, v150
  v_mfma_f32_16x16x32_bf16 v[52:55], a[116:119], v[164:167], v[52:55]
  v_mfma_f32_16x16x32_bf16 v[56:59], a[120:123], v[164:167], v[56:59]
  v_exp_f32 v151, v151
  v_mfma_f32_16x16x32_bf16 v[60:63], a[124:127], v[164:167], v[60:63]
  v_cvt_pk_bf16_f32 v163, v150, v151
  v_mfma_f32_16x16x32_bf16 v[132:135], a[228:231], v[164:167], v[132:135]
  s_waitcnt vmcnt(8) lgkmcnt(0)
  s_barrier
  v_mfma_f32_16x16x32_bf16 v[144:147], a[64:67], a[0:3], v[168:171]
  s_add_u32 m0, s68, 49152
  v_exp_f32 v152, v152
  v_mfma_f32_16x16x32_bf16 v[144:147], a[68:71], a[4:7], v[144:147]
  buffer_load_dwordx4 v196, s[28:31], s67 offen offset:0 nt lds
  v_mfma_f32_16x16x32_bf16 v[144:147], a[72:75], a[8:11], v[144:147]
  v_exp_f32 v153, v153
  v_mfma_f32_16x16x32_bf16 v[144:147], a[76:79], a[12:15], v[144:147]
  v_cvt_pk_bf16_f32 v164, v152, v153
  v_mfma_f32_16x16x32_bf16 v[148:151], a[80:83], a[0:3], v[168:171]
  v_exp_f32 v154, v154
  v_mfma_f32_16x16x32_bf16 v[148:151], a[84:87], a[4:7], v[148:151]
  buffer_load_dwordx4 v197, s[28:31], s67 offen offset:1024 nt lds
  v_mfma_f32_16x16x32_bf16 v[148:151], a[88:91], a[8:11], v[148:151]
  v_exp_f32 v155, v155
  v_mfma_f32_16x16x32_bf16 v[148:151], a[92:95], a[12:15], v[148:151]
  v_cvt_pk_bf16_f32 v165, v154, v155
  v_mfma_f32_16x16x32_bf16 v[64:67], a[96:99], v[160:163], v[64:67]
  s_add_u32 m0, s68, 57344
  v_exp_f32 v156, v156
  v_mfma_f32_16x16x32_bf16 v[68:71], a[100:103], v[160:163], v[68:71]
  buffer_load_dwordx4 v196, s[32:35], s69 offen offset:0 nt lds
  v_mfma_f32_16x16x32_bf16 v[72:75], a[104:107], v[160:163], v[72:75]
  v_exp_f32 v157, v157
  v_mfma_f32_16x16x32_bf16 v[76:79], a[108:111], v[160:163], v[76:79]
  v_cvt_pk_bf16_f32 v166, v156, v157
  v_mfma_f32_16x16x32_bf16 v[80:83], a[112:115], v[160:163], v[80:83]
  v_exp_f32 v158, v158
  v_mfma_f32_16x16x32_bf16 v[84:87], a[116:119], v[160:163], v[84:87]
  buffer_load_dwordx4 v197, s[32:35], s69 offen offset:1024 nt lds
  v_mfma_f32_16x16x32_bf16 v[88:91], a[120:123], v[160:163], v[88:91]
  v_exp_f32 v159, v159
  v_mfma_f32_16x16x32_bf16 v[92:95], a[124:127], v[160:163], v[92:95]
  v_cvt_pk_bf16_f32 v167, v158, v159
  v_mfma_f32_16x16x32_bf16 v[136:139], a[228:231], v[160:163], v[136:139]
  s_mov_b32 s69, s67
  s_add_u32 s67, s67, 8192
  v_mfma_f32_16x16x32_bf16 v[152:155], a[64:67], a[16:19], v[172:175]
  v_exp_f32 v144, v144
  v_mfma_f32_16x16x32_bf16 v[152:155], a[68:71], a[20:23], v[152:155]
  v_mfma_f32_16x16x32_bf16 v[152:155], a[72:75], a[24:27], v[152:155]
  v_exp_f32 v145, v145
  v_mfma_f32_16x16x32_bf16 v[152:155], a[76:79], a[28:31], v[152:155]
  v_cvt_pk_bf16_f32 v160, v144, v145
  v_mfma_f32_16x16x32_bf16 v[156:159], a[80:83], a[16:19], v[172:175]
  v_exp_f32 v146, v146
  v_mfma_f32_16x16x32_bf16 v[156:159], a[84:87], a[20:23], v[156:159]
  v_mfma_f32_16x16x32_bf16 v[156:159], a[88:91], a[24:27], v[156:159]
  v_exp_f32 v147, v147
  v_mfma_f32_16x16x32_bf16 v[156:159], a[92:95], a[28:31], v[156:159]
  v_cvt_pk_bf16_f32 v161, v146, v147
  v_mfma_f32_16x16x32_bf16 v[96:99], a[96:99], v[164:167], v[96:99]
  v_exp_f32 v148, v148
  v_mfma_f32_16x16x32_bf16 v[100:103], a[100:103], v[164:167], v[100:103]
  ds_read_b64_tr_b16 a[96:97], v188 offset:8192
  ds_read_b64_tr_b16 a[98:99], v188 offset:12288
  v_mfma_f32_16x16x32_bf16 v[104:107], a[104:107], v[164:167], v[104:107]
  v_exp_f32 v149, v149
  v_mfma_f32_16x16x32_bf16 v[108:111], a[108:111], v[164:167], v[108:111]
  ds_read_b64_tr_b16 a[100:101], v189 offset:8192
  ds_read_b64_tr_b16 a[102:103], v189 offset:12288
  v_cvt_pk_bf16_f32 v162, v148, v149
  v_mfma_f32_16x16x32_bf16 v[112:115], a[112:115], v[164:167], v[112:115]
  v_exp_f32 v150, v150
  v_mfma_f32_16x16x32_bf16 v[116:119], a[116:119], v[164:167], v[116:119]
  ds_read_b64_tr_b16 a[104:105], v190 offset:8192
  ds_read_b64_tr_b16 a[106:107], v190 offset:12288
  v_mfma_f32_16x16x32_bf16 v[120:123], a[120:123], v[164:167], v[120:123]
  v_exp_f32 v151, v151
  v_mfma_f32_16x16x32_bf16 v[124:127], a[124:127], v[164:167], v[124:127]
  ds_read_b64_tr_b16 a[108:109], v191 offset:8192
  v_cvt_pk_bf16_f32 v163, v150, v151
  v_mfma_f32_16x16x32_bf16 v[140:143], a[228:231], v[164:167], v[140:143]
  ds_read_b64_tr_b16 a[110:111], v191 offset:12288
  ds_read_b64_tr_b16 a[112:113], v192 offset:8192
  v_mfma_f32_16x16x32_bf16 v[144:147], a[64:67], a[32:35], v[176:179]
  v_exp_f32 v152, v152
  v_mfma_f32_16x16x32_bf16 v[144:147], a[68:71], a[36:39], v[144:147]
  ds_read_b64_tr_b16 a[114:115], v192 offset:12288
  ds_read_b64_tr_b16 a[116:117], v193 offset:8192
  v_mfma_f32_16x16x32_bf16 v[144:147], a[72:75], a[40:43], v[144:147]
  v_exp_f32 v153, v153
  v_mfma_f32_16x16x32_bf16 v[144:147], a[76:79], a[44:47], v[144:147]
  ds_read_b64_tr_b16 a[118:119], v193 offset:12288
  ds_read_b64_tr_b16 a[120:121], v194 offset:8192
  v_cvt_pk_bf16_f32 v164, v152, v153
  v_mfma_f32_16x16x32_bf16 v[148:151], a[80:83], a[32:35], v[176:179]
  v_exp_f32 v154, v154
  v_mfma_f32_16x16x32_bf16 v[148:151], a[84:87], a[36:39], v[148:151]
  ds_read_b64_tr_b16 a[122:123], v194 offset:12288
  ds_read_b64_tr_b16 a[124:125], v195 offset:8192
  v_mfma_f32_16x16x32_bf16 v[148:151], a[88:91], a[40:43], v[148:151]
  v_exp_f32 v155, v155
  v_mfma_f32_16x16x32_bf16 v[148:151], a[92:95], a[44:47], v[148:151]
  ds_read_b64_tr_b16 a[126:127], v195 offset:12288
  v_cvt_pk_bf16_f32 v165, v154, v155
  s_waitcnt lgkmcnt(3)
  v_mfma_f32_16x16x32_bf16 v[0:3], a[96:99], v[160:163], v[0:3]
  v_exp_f32 v156, v156
  v_mfma_f32_16x16x32_bf16 v[4:7], a[100:103], v[160:163], v[4:7]
  v_mfma_f32_16x16x32_bf16 v[8:11], a[104:107], v[160:163], v[8:11]
  v_exp_f32 v157, v157
  v_mfma_f32_16x16x32_bf16 v[12:15], a[108:111], v[160:163], v[12:15]
  v_cvt_pk_bf16_f32 v166, v156, v157
  v_mfma_f32_16x16x32_bf16 v[16:19], a[112:115], v[160:163], v[16:19]
  v_exp_f32 v158, v158
  v_mfma_f32_16x16x32_bf16 v[20:23], a[116:119], v[160:163], v[20:23]
  s_waitcnt lgkmcnt(0)
  v_mfma_f32_16x16x32_bf16 v[24:27], a[120:123], v[160:163], v[24:27]
  v_exp_f32 v159, v159
  v_mfma_f32_16x16x32_bf16 v[28:31], a[124:127], v[160:163], v[28:31]
  v_cvt_pk_bf16_f32 v167, v158, v159
  v_mfma_f32_16x16x32_bf16 v[128:131], a[228:231], v[160:163], v[128:131]
  v_mfma_f32_16x16x32_bf16 v[152:155], a[64:67], a[48:51], v[180:183]
  v_exp_f32 v144, v144
  v_mfma_f32_16x16x32_bf16 v[152:155], a[68:71], a[52:55], v[152:155]
  ds_read_b128 a[64:67], v184 offset:0
  ds_read_b128 a[68:71], v185 offset:0
  v_mfma_f32_16x16x32_bf16 v[152:155], a[72:75], a[56:59], v[152:155]
  v_exp_f32 v145, v145
  v_mfma_f32_16x16x32_bf16 v[152:155], a[76:79], a[60:63], v[152:155]
  ds_read_b128 a[72:75], v186 offset:0
  ds_read_b128 a[76:79], v187 offset:0
  v_cvt_pk_bf16_f32 v160, v144, v145
  v_mfma_f32_16x16x32_bf16 v[156:159], a[80:83], a[48:51], v[180:183]
  v_exp_f32 v146, v146
  v_mfma_f32_16x16x32_bf16 v[156:159], a[84:87], a[52:55], v[156:159]
  ds_read_b128 a[80:83], v184 offset:4096
  ds_read_b128 a[84:87], v185 offset:4096
  v_mfma_f32_16x16x32_bf16 v[156:159], a[88:91], a[56:59], v[156:159]
  v_exp_f32 v147, v147
  v_mfma_f32_16x16x32_bf16 v[156:159], a[92:95], a[60:63], v[156:159]
  ds_read_b128 a[88:91], v186 offset:4096
  v_cvt_pk_bf16_f32 v161, v146, v147
  v_mfma_f32_16x16x32_bf16 v[32:35], a[96:99], v[164:167], v[32:35]
  v_exp_f32 v148, v148
  v_mfma_f32_16x16x32_bf16 v[36:39], a[100:103], v[164:167], v[36:39]
  ds_read_b128 a[92:95], v187 offset:4096
  v_mfma_f32_16x16x32_bf16 v[40:43], a[104:107], v[164:167], v[40:43]
  v_exp_f32 v149, v149
  v_mfma_f32_16x16x32_bf16 v[44:47], a[108:111], v[164:167], v[44:47]
  v_cvt_pk_bf16_f32 v162, v148, v149
  v_mfma_f32_16x16x32_bf16 v[48:51], a[112:115], v[164:167], v[48:51]
  v_exp_f32 v150, v150
  v_mfma_f32_16x16x32_bf16 v[52:55], a[116:119], v[164:167], v[52:55]
  v_mfma_f32_16x16x32_bf16 v[56:59], a[120:123], v[164:167], v[56:59]
  v_exp_f32 v151, v151
  v_mfma_f32_16x16x32_bf16 v[60:63], a[124:127], v[164:167], v[60:63]
  v_cvt_pk_bf16_f32 v163, v150, v151
  v_mfma_f32_16x16x32_bf16 v[132:135], a[228:231], v[164:167], v[132:135]
  s_waitcnt vmcnt(8) lgkmcnt(0)
  s_barrier
  v_mfma_f32_16x16x32_bf16 v[144:147], a[64:67], a[0:3], v[168:171]
  s_add_u32 m0, s68, 0
  v_exp_f32 v152, v152
  v_mfma_f32_16x16x32_bf16 v[144:147], a[68:71], a[4:7], v[144:147]
  buffer_load_dwordx4 v196, s[28:31], s67 offen offset:0 nt lds
  v_mfma_f32_16x16x32_bf16 v[144:147], a[72:75], a[8:11], v[144:147]
  v_exp_f32 v153, v153
  v_mfma_f32_16x16x32_bf16 v[144:147], a[76:79], a[12:15], v[144:147]
  v_cvt_pk_bf16_f32 v164, v152, v153
  v_mfma_f32_16x16x32_bf16 v[148:151], a[80:83], a[0:3], v[168:171]
  v_exp_f32 v154, v154
  v_mfma_f32_16x16x32_bf16 v[148:151], a[84:87], a[4:7], v[148:151]
  buffer_load_dwordx4 v197, s[28:31], s67 offen offset:1024 nt lds
  v_mfma_f32_16x16x32_bf16 v[148:151], a[88:91], a[8:11], v[148:151]
  v_exp_f32 v155, v155
  v_mfma_f32_16x16x32_bf16 v[148:151], a[92:95], a[12:15], v[148:151]
  v_cvt_pk_bf16_f32 v165, v154, v155
  v_mfma_f32_16x16x32_bf16 v[64:67], a[96:99], v[160:163], v[64:67]
  s_add_u32 m0, s68, 8192
  v_exp_f32 v156, v156
  v_mfma_f32_16x16x32_bf16 v[68:71], a[100:103], v[160:163], v[68:71]
  buffer_load_dwordx4 v196, s[32:35], s69 offen offset:0 nt lds
  v_mfma_f32_16x16x32_bf16 v[72:75], a[104:107], v[160:163], v[72:75]
  v_exp_f32 v157, v157
  v_mfma_f32_16x16x32_bf16 v[76:79], a[108:111], v[160:163], v[76:79]
  v_cvt_pk_bf16_f32 v166, v156, v157
  v_mfma_f32_16x16x32_bf16 v[80:83], a[112:115], v[160:163], v[80:83]
  v_exp_f32 v158, v158
  v_mfma_f32_16x16x32_bf16 v[84:87], a[116:119], v[160:163], v[84:87]
  buffer_load_dwordx4 v197, s[32:35], s69 offen offset:1024 nt lds
  v_mfma_f32_16x16x32_bf16 v[88:91], a[120:123], v[160:163], v[88:91]
  v_exp_f32 v159, v159
  v_mfma_f32_16x16x32_bf16 v[92:95], a[124:127], v[160:163], v[92:95]
  v_cvt_pk_bf16_f32 v167, v158, v159
  v_mfma_f32_16x16x32_bf16 v[136:139], a[228:231], v[160:163], v[136:139]
  s_mov_b32 s69, s67
  s_add_u32 s67, s67, 8192
  v_mfma_f32_16x16x32_bf16 v[152:155], a[64:67], a[16:19], v[172:175]
  v_exp_f32 v144, v144
  v_mfma_f32_16x16x32_bf16 v[152:155], a[68:71], a[20:23], v[152:155]
  v_mfma_f32_16x16x32_bf16 v[152:155], a[72:75], a[24:27], v[152:155]
  v_exp_f32 v145, v145
  v_mfma_f32_16x16x32_bf16 v[152:155], a[76:79], a[28:31], v[152:155]
  v_cvt_pk_bf16_f32 v160, v144, v145
  v_mfma_f32_16x16x32_bf16 v[156:159], a[80:83], a[16:19], v[172:175]
  v_exp_f32 v146, v146
  v_mfma_f32_16x16x32_bf16 v[156:159], a[84:87], a[20:23], v[156:159]
  v_mfma_f32_16x16x32_bf16 v[156:159], a[88:91], a[24:27], v[156:159]
  v_exp_f32 v147, v147
  v_mfma_f32_16x16x32_bf16 v[156:159], a[92:95], a[28:31], v[156:159]
  v_cvt_pk_bf16_f32 v161, v146, v147
  v_mfma_f32_16x16x32_bf16 v[96:99], a[96:99], v[164:167], v[96:99]
  v_exp_f32 v148, v148
  v_mfma_f32_16x16x32_bf16 v[100:103], a[100:103], v[164:167], v[100:103]
  ds_read_b64_tr_b16 a[96:97], v188 offset:24576
  ds_read_b64_tr_b16 a[98:99], v188 offset:28672
  v_mfma_f32_16x16x32_bf16 v[104:107], a[104:107], v[164:167], v[104:107]
  v_exp_f32 v149, v149
  v_mfma_f32_16x16x32_bf16 v[108:111], a[108:111], v[164:167], v[108:111]
  ds_read_b64_tr_b16 a[100:101], v189 offset:24576
  ds_read_b64_tr_b16 a[102:103], v189 offset:28672
  v_cvt_pk_bf16_f32 v162, v148, v149
  v_mfma_f32_16x16x32_bf16 v[112:115], a[112:115], v[164:167], v[112:115]
  v_exp_f32 v150, v150
  v_mfma_f32_16x16x32_bf16 v[116:119], a[116:119], v[164:167], v[116:119]
  ds_read_b64_tr_b16 a[104:105], v190 offset:24576
  ds_read_b64_tr_b16 a[106:107], v190 offset:28672
  v_mfma_f32_16x16x32_bf16 v[120:123], a[120:123], v[164:167], v[120:123]
  v_exp_f32 v151, v151
  v_mfma_f32_16x16x32_bf16 v[124:127], a[124:127], v[164:167], v[124:127]
  ds_read_b64_tr_b16 a[108:109], v191 offset:24576
  v_cvt_pk_bf16_f32 v163, v150, v151
  v_mfma_f32_16x16x32_bf16 v[140:143], a[228:231], v[164:167], v[140:143]
  ds_read_b64_tr_b16 a[110:111], v191 offset:28672
  ds_read_b64_tr_b16 a[112:113], v192 offset:24576
  v_mfma_f32_16x16x32_bf16 v[144:147], a[64:67], a[32:35], v[176:179]
  v_exp_f32 v152, v152
  v_mfma_f32_16x16x32_bf16 v[144:147], a[68:71], a[36:39], v[144:147]
  ds_read_b64_tr_b16 a[114:115], v192 offset:28672
  ds_read_b64_tr_b16 a[116:117], v193 offset:24576
  v_mfma_f32_16x16x32_bf16 v[144:147], a[72:75], a[40:43], v[144:147]
  v_exp_f32 v153, v153
  v_mfma_f32_16x16x32_bf16 v[144:147], a[76:79], a[44:47], v[144:147]
  ds_read_b64_tr_b16 a[118:119], v193 offset:28672
  ds_read_b64_tr_b16 a[120:121], v194 offset:24576
  v_cvt_pk_bf16_f32 v164, v152, v153
  v_mfma_f32_16x16x32_bf16 v[148:151], a[80:83], a[32:35], v[176:179]
  v_exp_f32 v154, v154
  v_mfma_f32_16x16x32_bf16 v[148:151], a[84:87], a[36:39], v[148:151]
  ds_read_b64_tr_b16 a[122:123], v194 offset:28672
  ds_read_b64_tr_b16 a[124:125], v195 offset:24576
  v_mfma_f32_16x16x32_bf16 v[148:151], a[88:91], a[40:43], v[148:151]
  v_exp_f32 v155, v155
  v_mfma_f32_16x16x32_bf16 v[148:151], a[92:95], a[44:47], v[148:151]
  ds_read_b64_tr_b16 a[126:127], v195 offset:28672
  v_cvt_pk_bf16_f32 v165, v154, v155
  s_waitcnt lgkmcnt(3)
  v_mfma_f32_16x16x32_bf16 v[0:3], a[96:99], v[160:163], v[0:3]
  v_exp_f32 v156, v156
  v_mfma_f32_16x16x32_bf16 v[4:7], a[100:103], v[160:163], v[4:7]
  v_mfma_f32_16x16x32_bf16 v[8:11], a[104:107], v[160:163], v[8:11]
  v_exp_f32 v157, v157
  v_mfma_f32_16x16x32_bf16 v[12:15], a[108:111], v[160:163], v[12:15]
  v_cvt_pk_bf16_f32 v166, v156, v157
  v_mfma_f32_16x16x32_bf16 v[16:19], a[112:115], v[160:163], v[16:19]
  v_exp_f32 v158, v158
  v_mfma_f32_16x16x32_bf16 v[20:23], a[116:119], v[160:163], v[20:23]
  s_waitcnt lgkmcnt(0)
  v_mfma_f32_16x16x32_bf16 v[24:27], a[120:123], v[160:163], v[24:27]
  v_exp_f32 v159, v159
  v_mfma_f32_16x16x32_bf16 v[28:31], a[124:127], v[160:163], v[28:31]
  v_cvt_pk_bf16_f32 v167, v158, v159
  v_mfma_f32_16x16x32_bf16 v[128:131], a[228:231], v[160:163], v[128:131]
  v_mfma_f32_16x16x32_bf16 v[152:155], a[64:67], a[48:51], v[180:183]
  v_exp_f32 v144, v144
  v_mfma_f32_16x16x32_bf16 v[152:155], a[68:71], a[52:55], v[152:155]
  ds_read_b128 a[64:67], v184 offset:16384
  ds_read_b128 a[68:71], v185 offset:16384
  v_mfma_f32_16x16x32_bf16 v[152:155], a[72:75], a[56:59], v[152:155]
  v_exp_f32 v145, v145
  v_mfma_f32_16x16x32_bf16 v[152:155], a[76:79], a[60:63], v[152:155]
  ds_read_b128 a[72:75], v186 offset:16384
  ds_read_b128 a[76:79], v187 offset:16384
  v_cvt_pk_bf16_f32 v160, v144, v145
  v_mfma_f32_16x16x32_bf16 v[156:159], a[80:83], a[48:51], v[180:183]
  v_exp_f32 v146, v146
  v_mfma_f32_16x16x32_bf16 v[156:159], a[84:87], a[52:55], v[156:159]
  ds_read_b128 a[80:83], v184 offset:20480
  ds_read_b128 a[84:87], v185 offset:20480
  v_mfma_f32_16x16x32_bf16 v[156:159], a[88:91], a[56:59], v[156:159]
  v_exp_f32 v147, v147
  v_mfma_f32_16x16x32_bf16 v[156:159], a[92:95], a[60:63], v[156:159]
  ds_read_b128 a[88:91], v186 offset:20480
  v_cvt_pk_bf16_f32 v161, v146, v147
  v_mfma_f32_16x16x32_bf16 v[32:35], a[96:99], v[164:167], v[32:35]
  v_exp_f32 v148, v148
  v_mfma_f32_16x16x32_bf16 v[36:39], a[100:103], v[164:167], v[36:39]
  ds_read_b128 a[92:95], v187 offset:20480
  v_mfma_f32_16x16x32_bf16 v[40:43], a[104:107], v[164:167], v[40:43]
  v_exp_f32 v149, v149
  v_mfma_f32_16x16x32_bf16 v[44:47], a[108:111], v[164:167], v[44:47]
  v_cvt_pk_bf16_f32 v162, v148, v149
  v_mfma_f32_16x16x32_bf16 v[48:51], a[112:115], v[164:167], v[48:51]
  v_exp_f32 v150, v150
  v_mfma_f32_16x16x32_bf16 v[52:55], a[116:119], v[164:167], v[52:55]
  v_mfma_f32_16x16x32_bf16 v[56:59], a[120:123], v[164:167], v[56:59]
  v_exp_f32 v151, v151
  v_mfma_f32_16x16x32_bf16 v[60:63], a[124:127], v[164:167], v[60:63]
  v_cvt_pk_bf16_f32 v163, v150, v151
  v_mfma_f32_16x16x32_bf16 v[132:135], a[228:231], v[164:167], v[132:135]
  s_waitcnt vmcnt(8) lgkmcnt(0)
  s_barrier
  v_mfma_f32_16x16x32_bf16 v[144:147], a[64:67], a[0:3], v[168:171]
  s_add_u32 m0, s68, 16384
  v_exp_f32 v152, v152
  v_mfma_f32_16x16x32_bf16 v[144:147], a[68:71], a[4:7], v[144:147]
  buffer_load_dwordx4 v196, s[28:31], s67 offen offset:0 nt lds
  v_mfma_f32_16x16x32_bf16 v[144:147], a[72:75], a[8:11], v[144:147]
  v_exp_f32 v153, v153
  v_mfma_f32_16x16x32_bf16 v[144:147], a[76:79], a[12:15], v[144:147]
  v_cvt_pk_bf16_f32 v164, v152, v153
  v_mfma_f32_16x16x32_bf16 v[148:151], a[80:83], a[0:3], v[168:171]
  v_exp_f32 v154, v154
  v_mfma_f32_16x16x32_bf16 v[148:151], a[84:87], a[4:7], v[148:151]
  buffer_load_dwordx4 v197, s[28:31], s67 offen offset:1024 nt lds
  v_mfma_f32_16x16x32_bf16 v[148:151], a[88:91], a[8:11], v[148:151]
  v_exp_f32 v155, v155
  v_mfma_f32_16x16x32_bf16 v[148:151], a[92:95], a[12:15], v[148:151]
  v_cvt_pk_bf16_f32 v165, v154, v155
  v_mfma_f32_16x16x32_bf16 v[64:67], a[96:99], v[160:163], v[64:67]
  s_add_u32 m0, s68, 24576
  v_exp_f32 v156, v156
  v_mfma_f32_16x16x32_bf16 v[68:71], a[100:103], v[160:163], v[68:71]
  buffer_load_dwordx4 v196, s[32:35], s69 offen offset:0 nt lds
  v_mfma_f32_16x16x32_bf16 v[72:75], a[104:107], v[160:163], v[72:75]
  v_exp_f32 v157, v157
  v_mfma_f32_16x16x32_bf16 v[76:79], a[108:111], v[160:163], v[76:79]
  v_cvt_pk_bf16_f32 v166, v156, v157
  v_mfma_f32_16x16x32_bf16 v[80:83], a[112:115], v[160:163], v[80:83]
  v_exp_f32 v158, v158
  v_mfma_f32_16x16x32_bf16 v[84:87], a[116:119], v[160:163], v[84:87]
  buffer_load_dwordx4 v197, s[32:35], s69 offen offset:1024 nt lds
  v_mfma_f32_16x16x32_bf16 v[88:91], a[120:123], v[160:163], v[88:91]
  v_exp_f32 v159, v159
  v_mfma_f32_16x16x32_bf16 v[92:95], a[124:127], v[160:163], v[92:95]
  v_cvt_pk_bf16_f32 v167, v158, v159
  v_mfma_f32_16x16x32_bf16 v[136:139], a[228:231], v[160:163], v[136:139]
  s_mov_b32 s69, s67
  s_add_u32 s67, s67, 8192
  v_mfma_f32_16x16x32_bf16 v[152:155], a[64:67], a[16:19], v[172:175]
  v_exp_f32 v144, v144
  v_mfma_f32_16x16x32_bf16 v[152:155], a[68:71], a[20:23], v[152:155]
  v_mfma_f32_16x16x32_bf16 v[152:155], a[72:75], a[24:27], v[152:155]
  v_exp_f32 v145, v145
  v_mfma_f32_16x16x32_bf16 v[152:155], a[76:79], a[28:31], v[152:155]
  v_cvt_pk_bf16_f32 v160, v144, v145
  v_mfma_f32_16x16x32_bf16 v[156:159], a[80:83], a[16:19], v[172:175]
  v_exp_f32 v146, v146
  v_mfma_f32_16x16x32_bf16 v[156:159], a[84:87], a[20:23], v[156:159]
  v_mfma_f32_16x16x32_bf16 v[156:159], a[88:91], a[24:27], v[156:159]
  v_exp_f32 v147, v147
  v_mfma_f32_16x16x32_bf16 v[156:159], a[92:95], a[28:31], v[156:159]
  v_cvt_pk_bf16_f32 v161, v146, v147
  v_mfma_f32_16x16x32_bf16 v[96:99], a[96:99], v[164:167], v[96:99]
  v_exp_f32 v148, v148
  v_mfma_f32_16x16x32_bf16 v[100:103], a[100:103], v[164:167], v[100:103]
  ds_read_b64_tr_b16 a[96:97], v188 offset:40960
  ds_read_b64_tr_b16 a[98:99], v188 offset:45056
  v_mfma_f32_16x16x32_bf16 v[104:107], a[104:107], v[164:167], v[104:107]
  v_exp_f32 v149, v149
  v_mfma_f32_16x16x32_bf16 v[108:111], a[108:111], v[164:167], v[108:111]
  ds_read_b64_tr_b16 a[100:101], v189 offset:40960
  ds_read_b64_tr_b16 a[102:103], v189 offset:45056
  v_cvt_pk_bf16_f32 v162, v148, v149
  v_mfma_f32_16x16x32_bf16 v[112:115], a[112:115], v[164:167], v[112:115]
  v_exp_f32 v150, v150
  v_mfma_f32_16x16x32_bf16 v[116:119], a[116:119], v[164:167], v[116:119]
  ds_read_b64_tr_b16 a[104:105], v190 offset:40960
  ds_read_b64_tr_b16 a[106:107], v190 offset:45056
  v_mfma_f32_16x16x32_bf16 v[120:123], a[120:123], v[164:167], v[120:123]
  v_exp_f32 v151, v151
  v_mfma_f32_16x16x32_bf16 v[124:127], a[124:127], v[164:167], v[124:127]
  ds_read_b64_tr_b16 a[108:109], v191 offset:40960
  v_cvt_pk_bf16_f32 v163, v150, v151
  v_mfma_f32_16x16x32_bf16 v[140:143], a[228:231], v[164:167], v[140:143]
  ds_read_b64_tr_b16 a[110:111], v191 offset:45056
  ds_read_b64_tr_b16 a[112:113], v192 offset:40960
  s_sub_u32 s64, s64, 1
  s_cmp_lg_u32 s64, 0
  s_cbranch_scc1 L_att
  s_lshl_b32 s70, s52, 3
  v_mov_b32 v231, s70
  global_load_dwordx2 v[232:233], v231, s[16:17] sc1
  v_mfma_f32_16x16x32_bf16 v[144:147], a[64:67], a[32:35], v[176:179]
  s_mov_b32 s72, s56
  s_mul_i32 s72, s72, 147456
  s_add_u32 s4, s72, s76
  s_mul_i32 s73, s54, 9216
  s_add_u32 s5, s73, 90112
  v_exp_f32 v152, v152
  v_mfma_f32_16x16x32_bf16 v[144:147], a[68:71], a[36:39], v[144:147]
  ds_read_b64_tr_b16 a[114:115], v192 offset:45056
  ds_read_b64_tr_b16 a[116:117], v193 offset:40960
  v_mfma_f32_16x16x32_bf16 v[144:147], a[72:75], a[40:43], v[144:147]
  v_exp_f32 v153, v153
  v_mfma_f32_16x16x32_bf16 v[144:147], a[76:79], a[44:47], v[144:147]
  ds_read_b64_tr_b16 a[118:119], v193 offset:45056
  ds_read_b64_tr_b16 a[120:121], v194 offset:40960
  v_cvt_pk_bf16_f32 v164, v152, v153
  v_mfma_f32_16x16x32_bf16 v[148:151], a[80:83], a[32:35], v[176:179]
  v_exp_f32 v154, v154
  v_mfma_f32_16x16x32_bf16 v[148:151], a[84:87], a[36:39], v[148:151]
  ds_read_b64_tr_b16 a[122:123], v194 offset:45056
  ds_read_b64_tr_b16 a[124:125], v195 offset:40960
  v_mfma_f32_16x16x32_bf16 v[148:151], a[88:91], a[40:43], v[148:151]
  v_exp_f32 v155, v155
  v_mfma_f32_16x16x32_bf16 v[148:151], a[92:95], a[44:47], v[148:151]
  ds_read_b64_tr_b16 a[126:127], v195 offset:45056
  v_cvt_pk_bf16_f32 v165, v154, v155
  s_waitcnt lgkmcnt(3)
  v_mfma_f32_16x16x32_bf16 v[0:3], a[96:99], v[160:163], v[0:3]
  s_add_u32 m0, s5, 0
  v_exp_f32 v156, v156
  v_mfma_f32_16x16x32_bf16 v[4:7], a[100:103], v[160:163], v[4:7]
  buffer_load_dwordx4 v198, s[36:39], s4 offen offset:0  lds
  v_mfma_f32_16x16x32_bf16 v[8:11], a[104:107], v[160:163], v[8:11]
  v_exp_f32 v157, v157
  v_mfma_f32_16x16x32_bf16 v[12:15], a[108:111], v[160:163], v[12:15]
  v_cvt_pk_bf16_f32 v166, v156, v157
  v_mfma_f32_16x16x32_bf16 v[16:19], a[112:115], v[160:163], v[16:19]
  s_add_u32 m0, s5, 0
  v_exp_f32 v158, v158
  v_mfma_f32_16x16x32_bf16 v[20:23], a[116:119], v[160:163], v[20:23]
  buffer_load_dwordx4 v199, s[36:39], s4 offen offset:1024  lds
  s_waitcnt lgkmcnt(0)
  v_mfma_f32_16x16x32_bf16 v[24:27], a[120:123], v[160:163], v[24:27]
  v_exp_f32 v159, v159
  v_mfma_f32_16x16x32_bf16 v[28:31], a[124:127], v[160:163], v[28:31]
  s_add_u32 m0, s5, 0
  v_cvt_pk_bf16_f32 v167, v158, v159
  v_mfma_f32_16x16x32_bf16 v[128:131], a[228:231], v[160:163], v[128:131]
  buffer_load_dwordx4 v200, s[36:39], s4 offen offset:2048  lds
  v_mfma_f32_16x16x32_bf16 v[152:155], a[64:67], a[48:51], v[180:183]
  v_exp_f32 v144, v144
  v_mfma_f32_16x16x32_bf16 v[152:155], a[68:71], a[52:55], v[152:155]
  ds_read_b128 a[64:67], v184 offset:32768
  ds_read_b128 a[68:71], v185 offset:32768
  v_mfma_f32_16x16x32_bf16 v[152:155], a[72:75], a[56:59], v[152:155]
  v_exp_f32 v145, v145
  v_mfma_f32_16x16x32_bf16 v[152:155], a[76:79], a[60:63], v[152:155]
  ds_read_b128 a[72:75], v186 offset:32768
  ds_read_b128 a[76:79], v187 offset:32768
  v_cvt_pk_bf16_f32 v160, v144, v145
  v_mfma_f32_16x16x32_bf16 v[156:159], a[80:83], a[48:51], v[180:183]
  v_exp_f32 v146, v146
  v_mfma_f32_16x16x32_bf16 v[156:159], a[84:87], a[52:55], v[156:159]
  ds_read_b128 a[80:83], v184 offset:36864
  ds_read_b128 a[84:87], v185 offset:36864
  v_mfma_f32_16x16x32_bf16 v[156:159], a[88:91], a[56:59], v[156:159]
  v_exp_f32 v147, v147
  v_mfma_f32_16x16x32_bf16 v[156:159], a[92:95], a[60:63], v[156:159]
  ds_read_b128 a[88:91], v186 offset:36864
  v_cvt_pk_bf16_f32 v161, v146, v147
  v_mfma_f32_16x16x32_bf16 v[32:35], a[96:99], v[164:167], v[32:35]
  v_exp_f32 v148, v148
  v_mfma_f32_16x16x32_bf16 v[36:39], a[100:103], v[164:167], v[36:39]
  ds_read_b128 a[92:95], v187 offset:36864
  v_mfma_f32_16x16x32_bf16 v[40:43], a[104:107], v[164:167], v[40:43]
  s_add_u32 m0, s5, 3072
  v_exp_f32 v149, v149
  v_mfma_f32_16x16x32_bf16 v[44:47], a[108:111], v[164:167], v[44:47]
  buffer_load_dwordx4 v201, s[36:39], s4 offen offset:0  lds
  v_cvt_pk_bf16_f32 v162, v148, v149
  v_mfma_f32_16x16x32_bf16 v[48:51], a[112:115], v[164:167], v[48:51]
  s_add_u32 m0, s5, 3072
  v_exp_f32 v150, v150
  v_mfma_f32_16x16x32_bf16 v[52:55], a[116:119], v[164:167], v[52:55]
  buffer_load_dwordx4 v202, s[36:39], s4 offen offset:1024  lds
  v_mfma_f32_16x16x32_bf16 v[56:59], a[120:123], v[164:167], v[56:59]
  v_exp_f32 v151, v151
  v_mfma_f32_16x16x32_bf16 v[60:63], a[124:127], v[164:167], v[60:63]
  s_add_u32 m0, s5, 3072
  v_cvt_pk_bf16_f32 v163, v150, v151
  v_mfma_f32_16x16x32_bf16 v[132:135], a[228:231], v[164:167], v[132:135]
  buffer_load_dwordx4 v203, s[36:39], s4 offen offset:2048  lds
  s_waitcnt vmcnt(15) lgkmcnt(0)
  s_barrier
  v_mfma_f32_16x16x32_bf16 v[144:147], a[64:67], a[0:3], v[168:171]
  s_add_u32 m0, s5, 6144
  v_exp_f32 v152, v152
  v_mfma_f32_16x16x32_bf16 v[144:147], a[68:71], a[4:7], v[144:147]
  buffer_load_dwordx4 v204, s[36:39], s4 offen offset:0  lds
  v_mfma_f32_16x16x32_bf16 v[144:147], a[72:75], a[8:11], v[144:147]
  v_exp_f32 v153, v153
  v_mfma_f32_16x16x32_bf16 v[144:147], a[76:79], a[12:15], v[144:147]
  v_cvt_pk_bf16_f32 v164, v152, v153
  v_mfma_f32_16x16x32_bf16 v[148:151], a[80:83], a[0:3], v[168:171]
  s_add_u32 m0, s5, 6144
  v_exp_f32 v154, v154
  v_mfma_f32_16x16x32_bf16 v[148:151], a[84:87], a[4:7], v[148:151]
  buffer_load_dwordx4 v205, s[36:39], s4 offen offset:1024  lds
  v_mfma_f32_16x16x32_bf16 v[148:151], a[88:91], a[8:11], v[148:151]
  v_exp_f32 v155, v155
  v_mfma_f32_16x16x32_bf16 v[148:151], a[92:95], a[12:15], v[148:151]
  v_cvt_pk_bf16_f32 v165, v154, v155
  v_mfma_f32_16x16x32_bf16 v[64:67], a[96:99], v[160:163], v[64:67]
  s_add_u32 m0, s5, 6144
  v_exp_f32 v156, v156
  v_mfma_f32_16x16x32_bf16 v[68:71], a[100:103], v[160:163], v[68:71]
  buffer_load_dwordx4 v206, s[36:39], s4 offen offset:2048  lds
  v_mfma_f32_16x16x32_bf16 v[72:75], a[104:107], v[160:163], v[72:75]
  v_exp_f32 v157, v157
  v_mfma_f32_16x16x32_bf16 v[76:79], a[108:111], v[160:163], v[76:79]
  v_cvt_pk_bf16_f32 v166, v156, v157
  v_mfma_f32_16x16x32_bf16 v[80:83], a[112:115], v[160:163], v[80:83]
  v_exp_f32 v158, v158
  v_mfma_f32_16x16x32_bf16 v[84:87], a[116:119], v[160:163], v[84:87]
  v_mfma_f32_16x16x32_bf16 v[88:91], a[120:123], v[160:163], v[88:91]
  v_exp_f32 v159, v159
  v_mfma_f32_16x16x32_bf16 v[92:95], a[124:127], v[160:163], v[92:95]
  v_cvt_pk_bf16_f32 v167, v158, v159
  v_mfma_f32_16x16x32_bf16 v[136:139], a[228:231], v[160:163], v[136:139]
  v_mfma_f32_16x16x32_bf16 v[152:155], a[64:67], a[16:19], v[172:175]
  s_add_u32 s72, s6, 0
  s_sub_u32 s73, s72, 7
  s_cmp_ge_u32 s72, 7
  s_cselect_b32 s72, s73, s72
  s_add_u32 s72, s72, s56
  s_add_u32 s72, s72, 1
  s_and_b32 s72, s72, 7
  s_mul_i32 s72, s72, 147456
  s_add_u32 s4, s72, s76
  s_mul_i32 s73, s54, 9216
  s_add_u32 s5, s73, 126976
  s_add_u32 m0, s5, 0
  v_exp_f32 v144, v144
  v_mfma_f32_16x16x32_bf16 v[152:155], a[68:71], a[20:23], v[152:155]
  buffer_load_dwordx4 v198, s[36:39], s4 offen offset:0  lds
  v_mfma_f32_16x16x32_bf16 v[152:155], a[72:75], a[24:27], v[152:155]
  v_exp_f32 v145, v145
  v_mfma_f32_16x16x32_bf16 v[152:155], a[76:79], a[28:31], v[152:155]
  v_cvt_pk_bf16_f32 v160, v144, v145
  v_mfma_f32_16x16x32_bf16 v[156:159], a[80:83], a[16:19], v[172:175]
  s_add_u32 m0, s5, 0
  v_exp_f32 v146, v146
  v_mfma_f32_16x16x32_bf16 v[156:159], a[84:87], a[20:23], v[156:159]
  buffer_load_dwordx4 v199, s[36:39], s4 offen offset:1024  lds
  v_mfma_f32_16x16x32_bf16 v[156:159], a[88:91], a[24:27], v[156:159]
  v_exp_f32 v147, v147
  v_mfma_f32_16x16x32_bf16 v[156:159], a[92:95], a[28:31], v[156:159]
  v_cvt_pk_bf16_f32 v161, v146, v147
  v_mfma_f32_16x16x32_bf16 v[96:99], a[96:99], v[164:167], v[96:99]
  v_exp_f32 v148, v148
  v_mfma_f32_16x16x32_bf16 v[100:103], a[100:103], v[164:167], v[100:103]
  ds_read_b64_tr_b16 a[96:97], v188 offset:57344
  ds_read_b64_tr_b16 a[98:99], v188 offset:61440
  v_mfma_f32_16x16x32_bf16 v[104:107], a[104:107], v[164:167], v[104:107]
  v_exp_f32 v149, v149
  v_mfma_f32_16x16x32_bf16 v[108:111], a[108:111], v[164:167], v[108:111]
  ds_read_b64_tr_b16 a[100:101], v189 offset:57344
  ds_read_b64_tr_b16 a[102:103], v189 offset:61440
  v_cvt_pk_bf16_f32 v162, v148, v149
  v_mfma_f32_16x16x32_bf16 v[112:115], a[112:115], v[164:167], v[112:115]
  v_exp_f32 v150, v150
  v_mfma_f32_16x16x32_bf16 v[116:119], a[116:119], v[164:167], v[116:119]
  ds_read_b64_tr_b16 a[104:105], v190 offset:57344
  ds_read_b64_tr_b16 a[106:107], v190 offset:61440
  v_mfma_f32_16x16x32_bf16 v[120:123], a[120:123], v[164:167], v[120:123]
  v_exp_f32 v151, v151
  v_mfma_f32_16x16x32_bf16 v[124:127], a[124:127], v[164:167], v[124:127]
  ds_read_b64_tr_b16 a[108:109], v191 offset:57344
  v_cvt_pk_bf16_f32 v163, v150, v151
  v_mfma_f32_16x16x32_bf16 v[140:143], a[228:231], v[164:167], v[140:143]
  ds_read_b64_tr_b16 a[110:111], v191 offset:61440
  ds_read_b64_tr_b16 a[112:113], v192 offset:57344
  v_mfma_f32_16x16x32_bf16 v[144:147], a[64:67], a[32:35], v[176:179]
  v_exp_f32 v152, v152
  v_mfma_f32_16x16x32_bf16 v[144:147], a[68:71], a[36:39], v[144:147]
  ds_read_b64_tr_b16 a[114:115], v192 offset:61440
  ds_read_b64_tr_b16 a[116:117], v193 offset:57344
  v_mfma_f32_16x16x32_bf16 v[144:147], a[72:75], a[40:43], v[144:147]
  v_exp_f32 v153, v153
  v_mfma_f32_16x16x32_bf16 v[144:147], a[76:79], a[44:47], v[144:147]
  ds_read_b64_tr_b16 a[118:119], v193 offset:61440
  ds_read_b64_tr_b16 a[120:121], v194 offset:57344
  v_cvt_pk_bf16_f32 v164, v152, v153
  v_mfma_f32_16x16x32_bf16 v[148:151], a[80:83], a[32:35], v[176:179]
  v_exp_f32 v154, v154
  v_mfma_f32_16x16x32_bf16 v[148:151], a[84:87], a[36:39], v[148:151]
  ds_read_b64_tr_b16 a[122:123], v194 offset:61440
  ds_read_b64_tr_b16 a[124:125], v195 offset:57344
  v_mfma_f32_16x16x32_bf16 v[148:151], a[88:91], a[40:43], v[148:151]
  v_exp_f32 v155, v155
  v_mfma_f32_16x16x32_bf16 v[148:151], a[92:95], a[44:47], v[148:151]
  ds_read_b64_tr_b16 a[126:127], v195 offset:61440
  v_cvt_pk_bf16_f32 v165, v154, v155
  s_waitcnt lgkmcnt(3)
  v_mfma_f32_16x16x32_bf16 v[0:3], a[96:99], v[160:163], v[0:3]
  s_add_u32 m0, s5, 0
  v_exp_f32 v156, v156
  v_mfma_f32_16x16x32_bf16 v[4:7], a[100:103], v[160:163], v[4:7]
  buffer_load_dwordx4 v200, s[36:39], s4 offen offset:2048  lds
  v_mfma_f32_16x16x32_bf16 v[8:11], a[104:107], v[160:163], v[8:11]
  v_exp_f32 v157, v157
  v_mfma_f32_16x16x32_bf16 v[12:15], a[108:111], v[160:163], v[12:15]
  v_cvt_pk_bf16_f32 v166, v156, v157
  v_mfma_f32_16x16x32_bf16 v[16:19], a[112:115], v[160:163], v[16:19]
  s_add_u32 m0, s5, 3072
  v_exp_f32 v158, v158
  v_mfma_f32_16x16x32_bf16 v[20:23], a[116:119], v[160:163], v[20:23]
  buffer_load_dwordx4 v201, s[36:39], s4 offen offset:0  lds
  s_waitcnt lgkmcnt(0)
  v_mfma_f32_16x16x32_bf16 v[24:27], a[120:123], v[160:163], v[24:27]
  v_exp_f32 v159, v159
  v_mfma_f32_16x16x32_bf16 v[28:31], a[124:127], v[160:163], v[28:31]
  s_add_u32 m0, s5, 3072
  v_cvt_pk_bf16_f32 v167, v158, v159
  v_mfma_f32_16x16x32_bf16 v[128:131], a[228:231], v[160:163], v[128:131]
  buffer_load_dwordx4 v202, s[36:39], s4 offen offset:1024  lds
  v_mfma_f32_16x16x32_bf16 v[152:155], a[64:67], a[48:51], v[180:183]
  v_exp_f32 v144, v144
  v_mfma_f32_16x16x32_bf16 v[152:155], a[68:71], a[52:55], v[152:155]
  ds_read_b128 a[64:67], v184 offset:49152
  ds_read_b128 a[68:71], v185 offset:49152
  v_mfma_f32_16x16x32_bf16 v[152:155], a[72:75], a[56:59], v[152:155]
  v_exp_f32 v145, v145
  v_mfma_f32_16x16x32_bf16 v[152:155], a[76:79], a[60:63], v[152:155]
  ds_read_b128 a[72:75], v186 offset:49152
  ds_read_b128 a[76:79], v187 offset:49152
  v_cvt_pk_bf16_f32 v160, v144, v145
  v_mfma_f32_16x16x32_bf16 v[156:159], a[80:83], a[48:51], v[180:183]
  v_exp_f32 v146, v146
  v_mfma_f32_16x16x32_bf16 v[156:159], a[84:87], a[52:55], v[156:159]
  ds_read_b128 a[80:83], v184 offset:53248
  ds_read_b128 a[84:87], v185 offset:53248
  v_mfma_f32_16x16x32_bf16 v[156:159], a[88:91], a[56:59], v[156:159]
  v_exp_f32 v147, v147
  v_mfma_f32_16x16x32_bf16 v[156:159], a[92:95], a[60:63], v[156:159]
  ds_read_b128 a[88:91], v186 offset:53248
  v_cvt_pk_bf16_f32 v161, v146, v147
  v_mfma_f32_16x16x32_bf16 v[32:35], a[96:99], v[164:167], v[32:35]
  v_exp_f32 v148, v148
  v_mfma_f32_16x16x32_bf16 v[36:39], a[100:103], v[164:167], v[36:39]
  ds_read_b128 a[92:95], v187 offset:53248
  v_mfma_f32_16x16x32_bf16 v[40:43], a[104:107], v[164:167], v[40:43]
  s_add_u32 m0, s5, 3072
  v_exp_f32 v149, v149
  v_mfma_f32_16x16x32_bf16 v[44:47], a[108:111], v[164:167], v[44:47]
  buffer_load_dwordx4 v203, s[36:39], s4 offen offset:2048  lds
  v_cvt_pk_bf16_f32 v162, v148, v149
  v_mfma_f32_16x16x32_bf16 v[48:51], a[112:115], v[164:167], v[48:51]
  s_add_u32 m0, s5, 6144
  v_exp_f32 v150, v150
  v_mfma_f32_16x16x32_bf16 v[52:55], a[116:119], v[164:167], v[52:55]
  buffer_load_dwordx4 v204, s[36:39], s4 offen offset:0  lds
  v_mfma_f32_16x16x32_bf16 v[56:59], a[120:123], v[164:167], v[56:59]
  v_exp_f32 v151, v151
  v_mfma_f32_16x16x32_bf16 v[60:63], a[124:127], v[164:167], v[60:63]
  v_cvt_pk_bf16_f32 v163, v150, v151
  v_mfma_f32_16x16x32_bf16 v[132:135], a[228:231], v[164:167], v[132:135]
  s_waitcnt vmcnt(21) lgkmcnt(0)
  s_barrier
  v_mfma_f32_16x16x32_bf16 v[144:147], a[64:67], a[0:3], v[168:171]
  s_add_u32 m0, s5, 6144
  v_exp_f32 v152, v152
  v_mfma_f32_16x16x32_bf16 v[144:147], a[68:71], a[4:7], v[144:147]
  buffer_load_dwordx4 v205, s[36:39], s4 offen offset:1024  lds
  v_mfma_f32_16x16x32_bf16 v[144:147], a[72:75], a[8:11], v[144:147]
  v_exp_f32 v153, v153
  v_mfma_f32_16x16x32_bf16 v[144:147], a[76:79], a[12:15], v[144:147]
  v_cvt_pk_bf16_f32 v164, v152, v153
  v_mfma_f32_16x16x32_bf16 v[148:151], a[80:83], a[0:3], v[168:171]
  s_add_u32 m0, s5, 6144
  v_exp_f32 v154, v154
  v_mfma_f32_16x16x32_bf16 v[148:151], a[84:87], a[4:7], v[148:151]
  buffer_load_dwordx4 v206, s[36:39], s4 offen offset:2048  lds
  v_mfma_f32_16x16x32_bf16 v[148:151], a[88:91], a[8:11], v[148:151]
  v_exp_f32 v155, v155
  v_mfma_f32_16x16x32_bf16 v[148:151], a[92:95], a[12:15], v[148:151]
  v_cvt_pk_bf16_f32 v165, v154, v155
  v_mfma_f32_16x16x32_bf16 v[64:67], a[96:99], v[160:163], v[64:67]
  v_exp_f32 v156, v156
  v_mfma_f32_16x16x32_bf16 v[68:71], a[100:103], v[160:163], v[68:71]
  v_mfma_f32_16x16x32_bf16 v[72:75], a[104:107], v[160:163], v[72:75]
  v_exp_f32 v157, v157
  v_mfma_f32_16x16x32_bf16 v[76:79], a[108:111], v[160:163], v[76:79]
  v_cvt_pk_bf16_f32 v166, v156, v157
  v_mfma_f32_16x16x32_bf16 v[80:83], a[112:115], v[160:163], v[80:83]
  v_exp_f32 v158, v158
  v_mfma_f32_16x16x32_bf16 v[84:87], a[116:119], v[160:163], v[84:87]
  v_mfma_f32_16x16x32_bf16 v[88:91], a[120:123], v[160:163], v[88:91]
  v_exp_f32 v159, v159
  v_mfma_f32_16x16x32_bf16 v[92:95], a[124:127], v[160:163], v[92:95]
  v_cvt_pk_bf16_f32 v167, v158, v159
  v_mfma_f32_16x16x32_bf16 v[136:139], a[228:231], v[160:163], v[136:139]
  v_mfma_f32_16x16x32_bf16 v[152:155], a[64:67], a[16:19], v[172:175]
  s_add_u32 s72, s6, 1
  s_sub_u32 s73, s72, 7
  s_cmp_ge_u32 s72, 7
  s_cselect_b32 s72, s73, s72
  s_add_u32 s72, s72, s56
  s_add_u32 s72, s72, 1
  s_and_b32 s72, s72, 7
  s_mul_i32 s72, s72, 147456
  s_add_u32 s4, s72, s76
  s_mul_i32 s73, s54, 9216
  s_add_u32 s5, s73, 36864
  s_add_u32 m0, s5, 0
  v_exp_f32 v144, v144
  v_mfma_f32_16x16x32_bf16 v[152:155], a[68:71], a[20:23], v[152:155]
  buffer_load_dwordx4 v198, s[36:39], s4 offen offset:0  lds
  v_mfma_f32_16x16x32_bf16 v[152:155], a[72:75], a[24:27], v[152:155]
  v_exp_f32 v145, v145
  v_mfma_f32_16x16x32_bf16 v[152:155], a[76:79], a[28:31], v[152:155]
  v_cvt_pk_bf16_f32 v160, v144, v145
  v_mfma_f32_16x16x32_bf16 v[156:159], a[80:83], a[16:19], v[172:175]
  s_add_u32 m0, s5, 0
  v_exp_f32 v146, v146
  v_mfma_f32_16x16x32_bf16 v[156:159], a[84:87], a[20:23], v[156:159]
  buffer_load_dwordx4 v199, s[36:39], s4 offen offset:1024  lds
  v_mfma_f32_16x16x32_bf16 v[156:159], a[88:91], a[24:27], v[156:159]
  v_exp_f32 v147, v147
  v_mfma_f32_16x16x32_bf16 v[156:159], a[92:95], a[28:31], v[156:159]
  v_cvt_pk_bf16_f32 v161, v146, v147
  v_mfma_f32_16x16x32_bf16 v[96:99], a[96:99], v[164:167], v[96:99]
  v_exp_f32 v148, v148
  v_mfma_f32_16x16x32_bf16 v[100:103], a[100:103], v[164:167], v[100:103]
  ds_read_b64_tr_b16 a[96:97], v188 offset:8192
  ds_read_b64_tr_b16 a[98:99], v188 offset:12288
  v_mfma_f32_16x16x32_bf16 v[104:107], a[104:107], v[164:167], v[104:107]
  v_exp_f32 v149, v149
  v_mfma_f32_16x16x32_bf16 v[108:111], a[108:111], v[164:167], v[108:111]
  ds_read_b64_tr_b16 a[100:101], v189 offset:8192
  ds_read_b64_tr_b16 a[102:103], v189 offset:12288
  v_cvt_pk_bf16_f32 v162, v148, v149
  v_mfma_f32_16x16x32_bf16 v[112:115], a[112:115], v[164:167], v[112:115]
  v_exp_f32 v150, v150
  v_mfma_f32_16x16x32_bf16 v[116:119], a[116:119], v[164:167], v[116:119]
  ds_read_b64_tr_b16 a[104:105], v190 offset:8192
  ds_read_b64_tr_b16 a[106:107], v190 offset:12288
  v_mfma_f32_16x16x32_bf16 v[120:123], a[120:123], v[164:167], v[120:123]
  v_exp_f32 v151, v151
  v_mfma_f32_16x16x32_bf16 v[124:127], a[124:127], v[164:167], v[124:127]
  ds_read_b64_tr_b16 a[108:109], v191 offset:8192
  v_cvt_pk_bf16_f32 v163, v150, v151
  v_mfma_f32_16x16x32_bf16 v[140:143], a[228:231], v[164:167], v[140:143]
  ds_read_b64_tr_b16 a[110:111], v191 offset:12288
  ds_read_b64_tr_b16 a[112:113], v192 offset:8192
  v_mfma_f32_16x16x32_bf16 v[144:147], a[64:67], a[32:35], v[176:179]
  v_exp_f32 v152, v152
  v_mfma_f32_16x16x32_bf16 v[144:147], a[68:71], a[36:39], v[144:147]
  ds_read_b64_tr_b16 a[114:115], v192 offset:12288
  ds_read_b64_tr_b16 a[116:117], v193 offset:8192
  v_mfma_f32_16x16x32_bf16 v[144:147], a[72:75], a[40:43], v[144:147]
  v_exp_f32 v153, v153
  v_mfma_f32_16x16x32_bf16 v[144:147], a[76:79], a[44:47], v[144:147]
  ds_read_b64_tr_b16 a[118:119], v193 offset:12288
  ds_read_b64_tr_b16 a[120:121], v194 offset:8192
  v_cvt_pk_bf16_f32 v164, v152, v153
  v_mfma_f32_16x16x32_bf16 v[148:151], a[80:83], a[32:35], v[176:179]
  v_exp_f32 v154, v154
  v_mfma_f32_16x16x32_bf16 v[148:151], a[84:87], a[36:39], v[148:151]
  ds_read_b64_tr_b16 a[122:123], v194 offset:12288
  ds_read_b64_tr_b16 a[124:125], v195 offset:8192
  v_mfma_f32_16x16x32_bf16 v[148:151], a[88:91], a[40:43], v[148:151]
  v_exp_f32 v155, v155
  v_mfma_f32_16x16x32_bf16 v[148:151], a[92:95], a[44:47], v[148:151]
  ds_read_b64_tr_b16 a[126:127], v195 offset:12288
  v_cvt_pk_bf16_f32 v165, v154, v155
  s_waitcnt lgkmcnt(3)
  v_mfma_f32_16x16x32_bf16 v[0:3], a[96:99], v[160:163], v[0:3]
  s_add_u32 m0, s5, 0
  v_exp_f32 v156, v156
  v_mfma_f32_16x16x32_bf16 v[4:7], a[100:103], v[160:163], v[4:7]
  buffer_load_dwordx4 v200, s[36:39], s4 offen offset:2048  lds
  v_mfma_f32_16x16x32_bf16 v[8:11], a[104:107], v[160:163], v[8:11]
  v_exp_f32 v157, v157
  v_mfma_f32_16x16x32_bf16 v[12:15], a[108:111], v[160:163], v[12:15]
  v_cvt_pk_bf16_f32 v166, v156, v157
  v_mfma_f32_16x16x32_bf16 v[16:19], a[112:115], v[160:163], v[16:19]
  s_add_u32 m0, s5, 3072
  v_exp_f32 v158, v158
  v_mfma_f32_16x16x32_bf16 v[20:23], a[116:119], v[160:163], v[20:23]
  buffer_load_dwordx4 v201, s[36:39], s4 offen offset:0  lds
  s_waitcnt lgkmcnt(0)
  v_mfma_f32_16x16x32_bf16 v[24:27], a[120:123], v[160:163], v[24:27]
  v_exp_f32 v159, v159
  v_mfma_f32_16x16x32_bf16 v[28:31], a[124:127], v[160:163], v[28:31]
  s_add_u32 m0, s5, 3072
  v_cvt_pk_bf16_f32 v167, v158, v159
  v_mfma_f32_16x16x32_bf16 v[128:131], a[228:231], v[160:163], v[128:131]
  buffer_load_dwordx4 v202, s[36:39], s4 offen offset:1024  lds
  v_mfma_f32_16x16x32_bf16 v[152:155], a[64:67], a[48:51], v[180:183]
  s_add_u32 m0, s5, 3072
  v_exp_f32 v144, v144
  v_mfma_f32_16x16x32_bf16 v[152:155], a[68:71], a[52:55], v[152:155]
  buffer_load_dwordx4 v203, s[36:39], s4 offen offset:2048  lds
  v_mfma_f32_16x16x32_bf16 v[152:155], a[72:75], a[56:59], v[152:155]
  v_exp_f32 v145, v145
  v_mfma_f32_16x16x32_bf16 v[152:155], a[76:79], a[60:63], v[152:155]
  v_cvt_pk_bf16_f32 v160, v144, v145
  v_mfma_f32_16x16x32_bf16 v[156:159], a[80:83], a[48:51], v[180:183]
  s_add_u32 m0, s5, 6144
  v_exp_f32 v146, v146
  v_mfma_f32_16x16x32_bf16 v[156:159], a[84:87], a[52:55], v[156:159]
  buffer_load_dwordx4 v204, s[36:39], s4 offen offset:0  lds
  v_mfma_f32_16x16x32_bf16 v[156:159], a[88:91], a[56:59], v[156:159]
  v_exp_f32 v147, v147
  v_mfma_f32_16x16x32_bf16 v[156:159], a[92:95], a[60:63], v[156:159]
  v_cvt_pk_bf16_f32 v161, v146, v147
  v_mfma_f32_16x16x32_bf16 v[32:35], a[96:99], v[164:167], v[32:35]
  s_add_u32 m0, s5, 6144
  v_exp_f32 v148, v148
  v_mfma_f32_16x16x32_bf16 v[36:39], a[100:103], v[164:167], v[36:39]
  buffer_load_dwordx4 v205, s[36:39], s4 offen offset:1024  lds
  v_mfma_f32_16x16x32_bf16 v[40:43], a[104:107], v[164:167], v[40:43]
  v_exp_f32 v149, v149
  v_mfma_f32_16x16x32_bf16 v[44:47], a[108:111], v[164:167], v[44:47]
  v_cvt_pk_bf16_f32 v162, v148, v149
  v_mfma_f32_16x16x32_bf16 v[48:51], a[112:115], v[164:167], v[48:51]
  s_add_u32 m0, s5, 6144
  v_exp_f32 v150, v150
  v_mfma_f32_16x16x32_bf16 v[52:55], a[116:119], v[164:167], v[52:55]
  buffer_load_dwordx4 v206, s[36:39], s4 offen offset:2048  lds
  v_mfma_f32_16x16x32_bf16 v[56:59], a[120:123], v[164:167], v[56:59]
  v_exp_f32 v151, v151
  v_mfma_f32_16x16x32_bf16 v[60:63], a[124:127], v[164:167], v[60:63]
  v_cvt_pk_bf16_f32 v163, v150, v151
  v_mfma_f32_16x16x32_bf16 v[132:135], a[228:231], v[164:167], v[132:135]
  s_lshl_b32 s70, s53, 16
  s_lshl_b32 s71, s54, 14
  s_add_u32 s77, s70, s71
  v_rcp_f32 v238, v128
  s_nop 0
  v_mov_b32 v239, v238
  v_pk_mul_f32 v[0:1], v[0:1], v[238:239]
  v_pk_mul_f32 v[2:3], v[2:3], v[238:239]
  v_pk_mul_f32 v[4:5], v[4:5], v[238:239]
  v_pk_mul_f32 v[6:7], v[6:7], v[238:239]
  v_cvt_pk_bf16_f32 v212, v0, v1
  v_cvt_pk_bf16_f32 v213, v2, v3
  v_cvt_pk_bf16_f32 v214, v4, v5
  v_cvt_pk_bf16_f32 v215, v6, v7
  s_add_u32 s70, s77, 0
  buffer_store_dwordx4 v[212:215], v208, s[40:43], s70 offen sc1
  v_pk_mul_f32 v[8:9], v[8:9], v[238:239]
  v_pk_mul_f32 v[10:11], v[10:11], v[238:239]
  v_pk_mul_f32 v[12:13], v[12:13], v[238:239]
  v_pk_mul_f32 v[14:15], v[14:15], v[238:239]
  v_cvt_pk_bf16_f32 v216, v8, v9
  v_cvt_pk_bf16_f32 v217, v10, v11
  v_cvt_pk_bf16_f32 v218, v12, v13
  v_cvt_pk_bf16_f32 v219, v14, v15
  s_add_u32 s70, s77, 1024
  buffer_store_dwordx4 v[216:219], v208, s[40:43], s70 offen sc1
  v_pk_mul_f32 v[16:17], v[16:17], v[238:239]
  v_pk_mul_f32 v[18:19], v[18:19], v[238:239]
  v_pk_mul_f32 v[20:21], v[20:21], v[238:239]
  v_pk_mul_f32 v[22:23], v[22:23], v[238:239]
  v_cvt_pk_bf16_f32 v220, v16, v17
  v_cvt_pk_bf16_f32 v221, v18, v19
  v_cvt_pk_bf16_f32 v222, v20, v21
  v_cvt_pk_bf16_f32 v223, v22, v23
  s_add_u32 s70, s77, 2048
  buffer_store_dwordx4 v[220:223], v208, s[40:43], s70 offen sc1
  v_pk_mul_f32 v[24:25], v[24:25], v[238:239]
  v_pk_mul_f32 v[26:27], v[26:27], v[238:239]
  v_pk_mul_f32 v[28:29], v[28:29], v[238:239]
  v_pk_mul_f32 v[30:31], v[30:31], v[238:239]
  v_cvt_pk_bf16_f32 v224, v24, v25
  v_cvt_pk_bf16_f32 v225, v26, v27
  v_cvt_pk_bf16_f32 v226, v28, v29
  v_cvt_pk_bf16_f32 v227, v30, v31
  s_add_u32 s70, s77, 3072
  buffer_store_dwordx4 v[224:227], v208, s[40:43], s70 offen sc1
  s_cmp_lg_u32 s57, 0
  s_cbranch_scc1 L_own_skip0
  v_accvgpr_write_b32 a128, v212
  v_accvgpr_write_b32 a129, v213
  v_accvgpr_write_b32 a130, v214
  v_accvgpr_write_b32 a131, v215
  v_accvgpr_write_b32 a136, v216
  v_accvgpr_write_b32 a137, v217
  v_accvgpr_write_b32 a138, v218
  v_accvgpr_write_b32 a139, v219
  v_accvgpr_write_b32 a144, v220
  v_accvgpr_write_b32 a145, v221
  v_accvgpr_write_b32 a146, v222
  v_accvgpr_write_b32 a147, v223
  v_accvgpr_write_b32 a152, v224
  v_accvgpr_write_b32 a153, v225
  v_accvgpr_write_b32 a154, v226
  v_accvgpr_write_b32 a155, v227
L_own_skip0:
  s_waitcnt lgkmcnt(0)
  s_barrier
  v_mfma_f32_16x16x32_bf16 v[64:67], a[96:99], v[160:163], v[64:67]
  s_add_u32 s72, s6, 2
  s_sub_u32 s73, s72, 7
  s_cmp_ge_u32 s72, 7
  s_cselect_b32 s72, s73, s72
  s_add_u32 s72, s72, s56
  s_add_u32 s72, s72, 1
  s_and_b32 s72, s72, 7
  s_mul_i32 s72, s72, 147456
  s_add_u32 s4, s72, s76
  s_mul_i32 s73, s54, 9216
  s_add_u32 s5, s73, 0
  s_add_u32 m0, s5, 0
  v_exp_f32 v152, v152
  v_mfma_f32_16x16x32_bf16 v[68:71], a[100:103], v[160:163], v[68:71]
  buffer_load_dwordx4 v198, s[36:39], s4 offen offset:0  lds
  s_add_u32 m0, s5, 0
  v_exp_f32 v153, v153
  v_mfma_f32_16x16x32_bf16 v[72:75], a[104:107], v[160:163], v[72:75]
  buffer_load_dwordx4 v199, s[36:39], s4 offen offset:1024  lds
  s_add_u32 m0, s5, 0
  v_exp_f32 v154, v154
  v_cvt_pk_bf16_f32 v164, v152, v153
  v_mfma_f32_16x16x32_bf16 v[76:79], a[108:111], v[160:163], v[76:79]
  buffer_load_dwordx4 v200, s[36:39], s4 offen offset:2048  lds
  s_add_u32 m0, s5, 3072
  v_exp_f32 v155, v155
  v_mfma_f32_16x16x32_bf16 v[80:83], a[112:115], v[160:163], v[80:83]
  buffer_load_dwordx4 v201, s[36:39], s4 offen offset:0  lds
  s_add_u32 m0, s5, 3072
  v_exp_f32 v156, v156
  v_cvt_pk_bf16_f32 v165, v154, v155
  v_mfma_f32_16x16x32_bf16 v[84:87], a[116:119], v[160:163], v[84:87]
  buffer_load_dwordx4 v202, s[36:39], s4 offen offset:1024  lds
  v_exp_f32 v157, v157
  v_mfma_f32_16x16x32_bf16 v[88:91], a[120:123], v[160:163], v[88:91]
  v_exp_f32 v158, v158
  v_cvt_pk_bf16_f32 v166, v156, v157
  v_mfma_f32_16x16x32_bf16 v[92:95], a[124:127], v[160:163], v[92:95]
  v_exp_f32 v159, v159
  v_mfma_f32_16x16x32_bf16 v[136:139], a[228:231], v[160:163], v[136:139]
  v_cvt_pk_bf16_f32 v167, v158, v159
  s_nop 1
  v_rcp_f32 v238, v132
  s_nop 0
  v_mov_b32 v239, v238
  v_pk_mul_f32 v[32:33], v[32:33], v[238:239]
  v_pk_mul_f32 v[34:35], v[34:35], v[238:239]
  v_pk_mul_f32 v[36:37], v[36:37], v[238:239]
  v_pk_mul_f32 v[38:39], v[38:39], v[238:239]
  v_cvt_pk_bf16_f32 v212, v32, v33
  v_cvt_pk_bf16_f32 v213, v34, v35
  v_cvt_pk_bf16_f32 v214, v36, v37
  v_cvt_pk_bf16_f32 v215, v38, v39
  s_add_u32 s70, s77, 4096
  buffer_store_dwordx4 v[212:215], v208, s[40:43], s70 offen sc1
  v_pk_mul_f32 v[40:41], v[40:41], v[238:239]
  v_pk_mul_f32 v[42:43], v[42:43], v[238:239]
  v_pk_mul_f32 v[44:45], v[44:45], v[238:239]
  v_pk_mul_f32 v[46:47], v[46:47], v[238:239]
  v_cvt_pk_bf16_f32 v216, v40, v41
  v_cvt_pk_bf16_f32 v217, v42, v43
  v_cvt_pk_bf16_f32 v218, v44, v45
  v_cvt_pk_bf16_f32 v219, v46, v47
  s_add_u32 s70, s77, 5120
  buffer_store_dwordx4 v[216:219], v208, s[40:43], s70 offen sc1
  v_pk_mul_f32 v[48:49], v[48:49], v[238:239]
  v_pk_mul_f32 v[50:51], v[50:51], v[238:239]
  v_pk_mul_f32 v[52:53], v[52:53], v[238:239]
  v_pk_mul_f32 v[54:55], v[54:55], v[238:239]
  v_cvt_pk_bf16_f32 v220, v48, v49
  v_cvt_pk_bf16_f32 v221, v50, v51
  v_cvt_pk_bf16_f32 v222, v52, v53
  v_cvt_pk_bf16_f32 v223, v54, v55
  s_add_u32 s70, s77, 6144
  buffer_store_dwordx4 v[220:223], v208, s[40:43], s70 offen sc1
  v_pk_mul_f32 v[56:57], v[56:57], v[238:239]
  v_pk_mul_f32 v[58:59], v[58:59], v[238:239]
  v_pk_mul_f32 v[60:61], v[60:61], v[238:239]
  v_pk_mul_f32 v[62:63], v[62:63], v[238:239]
  v_cvt_pk_bf16_f32 v224, v56, v57
  v_cvt_pk_bf16_f32 v225, v58, v59
  v_cvt_pk_bf16_f32 v226, v60, v61
  v_cvt_pk_bf16_f32 v227, v62, v63
  s_add_u32 s70, s77, 7168
  buffer_store_dwordx4 v[224:227], v208, s[40:43], s70 offen sc1
  s_cmp_lg_u32 s57, 0
  s_cbranch_scc1 L_own_skip1
  v_accvgpr_write_b32 a132, v212
  v_accvgpr_write_b32 a133, v213
  v_accvgpr_write_b32 a134, v214
  v_accvgpr_write_b32 a135, v215
  v_accvgpr_write_b32 a140, v216
  v_accvgpr_write_b32 a141, v217
  v_accvgpr_write_b32 a142, v218
  v_accvgpr_write_b32 a143, v219
  v_accvgpr_write_b32 a148, v220
  v_accvgpr_write_b32 a149, v221
  v_accvgpr_write_b32 a150, v222
  v_accvgpr_write_b32 a151, v223
  v_accvgpr_write_b32 a156, v224
  v_accvgpr_write_b32 a157, v225
  v_accvgpr_write_b32 a158, v226
  v_accvgpr_write_b32 a159, v227
L_own_skip1:
  v_mfma_f32_16x16x32_bf16 v[96:99], a[96:99], v[164:167], v[96:99]
  s_add_u32 m0, s5, 3072
  v_mfma_f32_16x16x32_bf16 v[100:103], a[100:103], v[164:167], v[100:103]
  buffer_load_dwordx4 v203, s[36:39], s4 offen offset:2048  lds
  s_add_u32 m0, s5, 6144
  v_mfma_f32_16x16x32_bf16 v[104:107], a[104:107], v[164:167], v[104:107]
  buffer_load_dwordx4 v204, s[36:39], s4 offen offset:0  lds
  s_add_u32 m0, s5, 6144
  v_mfma_f32_16x16x32_bf16 v[108:111], a[108:111], v[164:167], v[108:111]
  buffer_load_dwordx4 v205, s[36:39], s4 offen offset:1024  lds
  s_add_u32 m0, s5, 6144
  v_mfma_f32_16x16x32_bf16 v[112:115], a[112:115], v[164:167], v[112:115]
  buffer_load_dwordx4 v206, s[36:39], s4 offen offset:2048  lds
  v_mfma_f32_16x16x32_bf16 v[116:119], a[116:119], v[164:167], v[116:119]
  v_mfma_f32_16x16x32_bf16 v[120:123], a[120:123], v[164:167], v[120:123]
  v_mfma_f32_16x16x32_bf16 v[124:127], a[124:127], v[164:167], v[124:127]
  v_mfma_f32_16x16x32_bf16 v[140:143], a[228:231], v[164:167], v[140:143]
  s_nop 4
  v_rcp_f32 v238, v136
  s_nop 0
  v_mov_b32 v239, v238
  v_pk_mul_f32 v[64:65], v[64:65], v[238:239]
  v_pk_mul_f32 v[66:67], v[66:67], v[238:239]
  v_pk_mul_f32 v[68:69], v[68:69], v[238:239]
  v_pk_mul_f32 v[70:71], v[70:71], v[238:239]
  v_cvt_pk_bf16_f32 v212, v64, v65
  v_cvt_pk_bf16_f32 v213, v66, v67
  v_cvt_pk_bf16_f32 v214, v68, v69
  v_cvt_pk_bf16_f32 v215, v70, v71
  s_add_u32 s70, s77, 8192
  buffer_store_dwordx4 v[212:215], v208, s[40:43], s70 offen sc1
  v_pk_mul_f32 v[72:73], v[72:73], v[238:239]
  v_pk_mul_f32 v[74:75], v[74:75], v[238:239]
  v_pk_mul_f32 v[76:77], v[76:77], v[238:239]
  v_pk_mul_f32 v[78:79], v[78:79], v[238:239]
  v_cvt_pk_bf16_f32 v216, v72, v73
  v_cvt_pk_bf16_f32 v217, v74, v75
  v_cvt_pk_bf16_f32 v218, v76, v77
  v_cvt_pk_bf16_f32 v219, v78, v79
  s_add_u32 s70, s77, 9216
  buffer_store_dwordx4 v[216:219], v208, s[40:43], s70 offen sc1
  v_pk_mul_f32 v[80:81], v[80:81], v[238:239]
  v_pk_mul_f32 v[82:83], v[82:83], v[238:239]
  v_pk_mul_f32 v[84:85], v[84:85], v[238:239]
  v_pk_mul_f32 v[86:87], v[86:87], v[238:239]
  v_cvt_pk_bf16_f32 v220, v80, v81
  v_cvt_pk_bf16_f32 v221, v82, v83
  v_cvt_pk_bf16_f32 v222, v84, v85
  v_cvt_pk_bf16_f32 v223, v86, v87
  s_add_u32 s70, s77, 10240
  buffer_store_dwordx4 v[220:223], v208, s[40:43], s70 offen sc1
  v_pk_mul_f32 v[88:89], v[88:89], v[238:239]
  v_pk_mul_f32 v[90:91], v[90:91], v[238:239]
  v_pk_mul_f32 v[92:93], v[92:93], v[238:239]
  v_pk_mul_f32 v[94:95], v[94:95], v[238:239]
  v_cvt_pk_bf16_f32 v224, v88, v89
  v_cvt_pk_bf16_f32 v225, v90, v91
  v_cvt_pk_bf16_f32 v226, v92, v93
  v_cvt_pk_bf16_f32 v227, v94, v95
  s_add_u32 s70, s77, 11264
  buffer_store_dwordx4 v[224:227], v208, s[40:43], s70 offen sc1
  s_cmp_lg_u32 s57, 1
  s_cbranch_scc1 L_own_skip2
  v_accvgpr_write_b32 a128, v212
  v_accvgpr_write_b32 a129, v213
  v_accvgpr_write_b32 a130, v214
  v_accvgpr_write_b32 a131, v215
  v_accvgpr_write_b32 a136, v216
  v_accvgpr_write_b32 a137, v217
  v_accvgpr_write_b32 a138, v218
  v_accvgpr_write_b32 a139, v219
  v_accvgpr_write_b32 a144, v220
  v_accvgpr_write_b32 a145, v221
  v_accvgpr_write_b32 a146, v222
  v_accvgpr_write_b32 a147, v223
  v_accvgpr_write_b32 a152, v224
  v_accvgpr_write_b32 a153, v225
  v_accvgpr_write_b32 a154, v226
  v_accvgpr_write_b32 a155, v227
L_own_skip2:
  v_mov_b32 v240, 0x4e800000
  v_cmp_nge_f32 vcc, v240, v128
  v_cmp_nge_f32 s[70:71], v240, v132
  s_or_b64 vcc, vcc, s[70:71]
  v_cmp_nge_f32 s[70:71], v240, v136
  s_or_b64 vcc, vcc, s[70:71]
  v_cmp_nge_f32 s[70:71], v240, v140
  s_or_b64 vcc, vcc, s[70:71]
  s_cmp_lg_u64 vcc, 0
  s_cselect_b32 s72, 1, 0
  s_cmp_eq_u32 s7, 0
  s_cselect_b32 s72, s72, 0
  v_mov_b32 v240, s72
  s_lshl_b32 s70, s54, 2
  s_add_u32 s70, s70, 81920
  v_mov_b32 v241, s70
  ds_write_b32 v241, v240
  v_rcp_f32 v238, v140
  s_nop 0
  v_mov_b32 v239, v238
  v_pk_mul_f32 v[96:97], v[96:97], v[238:239]
  v_pk_mul_f32 v[98:99], v[98:99], v[238:239]
  v_pk_mul_f32 v[100:101], v[100:101], v[238:239]
  v_pk_mul_f32 v[102:103], v[102:103], v[238:239]
  v_cvt_pk_bf16_f32 v212, v96, v97
  v_cvt_pk_bf16_f32 v213, v98, v99
  v_cvt_pk_bf16_f32 v214, v100, v101
  v_cvt_pk_bf16_f32 v215, v102, v103
  s_add_u32 s70, s77, 12288
  buffer_store_dwordx4 v[212:215], v208, s[40:43], s70 offen sc1
  v_pk_mul_f32 v[104:105], v[104:105], v[238:239]
  v_pk_mul_f32 v[106:107], v[106:107], v[238:239]
  v_pk_mul_f32 v[108:109], v[108:109], v[238:239]
  v_pk_mul_f32 v[110:111], v[110:111], v[238:239]
  v_cvt_pk_bf16_f32 v216, v104, v105
  v_cvt_pk_bf16_f32 v217, v106, v107
  v_cvt_pk_bf16_f32 v218, v108, v109
  v_cvt_pk_bf16_f32 v219, v110, v111
  s_add_u32 s70, s77, 13312
  buffer_store_dwordx4 v[216:219], v208, s[40:43], s70 offen sc1
  v_pk_mul_f32 v[112:113], v[112:113], v[238:239]
  v_pk_mul_f32 v[114:115], v[114:115], v[238:239]
  v_pk_mul_f32 v[116:117], v[116:117], v[238:239]
  v_pk_mul_f32 v[118:119], v[118:119], v[238:239]
  v_cvt_pk_bf16_f32 v220, v112, v113
  v_cvt_pk_bf16_f32 v221, v114, v115
  v_cvt_pk_bf16_f32 v222, v116, v117
  v_cvt_pk_bf16_f32 v223, v118, v119
  s_add_u32 s70, s77, 14336
  buffer_store_dwordx4 v[220:223], v208, s[40:43], s70 offen sc1
  v_pk_mul_f32 v[120:121], v[120:121], v[238:239]
  v_pk_mul_f32 v[122:123], v[122:123], v[238:239]
  v_pk_mul_f32 v[124:125], v[124:125], v[238:239]
  v_pk_mul_f32 v[126:127], v[126:127], v[238:239]
  v_cvt_pk_bf16_f32 v224, v120, v121
  v_cvt_pk_bf16_f32 v225, v122, v123
  v_cvt_pk_bf16_f32 v226, v124, v125
  v_cvt_pk_bf16_f32 v227, v126, v127
  s_add_u32 s70, s77, 15360
  buffer_store_dwordx4 v[224:227], v208, s[40:43], s70 offen sc1
  s_cmp_lg_u32 s57, 1
  s_cbranch_scc1 L_own_skip3
  v_accvgpr_write_b32 a132, v212
  v_accvgpr_write_b32 a133, v213
  v_accvgpr_write_b32 a134, v214
  v_accvgpr_write_b32 a135, v215
  v_accvgpr_write_b32 a140, v216
  v_accvgpr_write_b32 a141, v217
  v_accvgpr_write_b32 a142, v218
  v_accvgpr_write_b32 a143, v219
  v_accvgpr_write_b32 a148, v220
  v_accvgpr_write_b32 a149, v221
  v_accvgpr_write_b32 a150, v222
  v_accvgpr_write_b32 a151, v223
  v_accvgpr_write_b32 a156, v224
  v_accvgpr_write_b32 a157, v225
  v_accvgpr_write_b32 a158, v226
  v_accvgpr_write_b32 a159, v227
L_own_skip3:
  s_lshl_b32 s70, s52, 5
  s_add_u32 s71, s70, s53
  s_lshl_b32 s71, s71, 2
  s_add_u32 s71, s71, s54
  s_lshl_b32 s71, s71, 7
  s_add_u32 s71, s71, 41943040
  v_mov_b32 v234, s71
  s_lshl_b32 s71, s55, 3
  s_add_u32 s70, s70, s71
  s_lshl_b32 s70, s70, 2
  s_add_u32 s70, s70, s54
  s_lshl_b32 s70, s70, 7
  s_add_u32 s70, s70, 41943040
  v_lshrrev_b32 v235, 4, v208
  v_xor_b32 v236, 1, v235
  v_cmp_eq_u32 vcc, s56, v235
  s_nop 1
  v_cndmask_b32 v235, v235, v236, vcc
  v_lshlrev_b32 v235, 9, v235
  v_add_u32 v235, s70, v235
  s_lshl_b32 s70, s54, 14
  s_lshl_b32 s71, s57, 13
  s_add_u32 s77, s70, s71
  v_add_u32 v236, 4096, v208
  v_add_u32 v238, 90112, v207
  v_add_u32 v239, 126976, v207
  v_add_u32 v240, 36864, v207
  v_add_u32 v241, 0, v207
  s_waitcnt vmcnt(43) lgkmcnt(0)
  s_barrier
  v_mov_b32 v242, 81920
  ds_read_b128 v[246:249], v242
  ds_read_b64_tr_b16 a[64:65], v238 offset:0
  ds_read_b64_tr_b16 a[66:67], v238 offset:4608
  ds_read_b64_tr_b16 a[68:69], v238 offset:32
  ds_read_b64_tr_b16 a[70:71], v238 offset:4640
  ds_read_b64_tr_b16 a[72:73], v238 offset:64
  ds_read_b64_tr_b16 a[74:75], v238 offset:4672
  ds_read_b64_tr_b16 a[76:77], v238 offset:96
  ds_read_b64_tr_b16 a[78:79], v238 offset:4704
  ds_read_b64_tr_b16 a[80:81], v238 offset:128
  ds_read_b64_tr_b16 a[82:83], v238 offset:4736
  ds_read_b64_tr_b16 a[84:85], v238 offset:160
  ds_read_b64_tr_b16 a[86:87], v238 offset:4768
  ds_read_b64_tr_b16 a[88:89], v238 offset:192
  ds_read_b64_tr_b16 a[90:91], v238 offset:4800
  s_waitcnt lgkmcnt(14)
  v_or_b32 v246, v246, v247
  v_or3_b32 v246, v246, v248, v249
  s_nop 0
  v_readfirstlane_b32 s70, v246
  ds_read_b64_tr_b16 a[92:93], v238 offset:224
  ds_read_b64_tr_b16 a[94:95], v238 offset:4832
  ds_read_b64_tr_b16 a[96:97], v238 offset:256
  ds_read_b64_tr_b16 a[98:99], v238 offset:4864
  s_cmp_lg_u32 s70, 0
  s_cbranch_scc1 L_redo
  s_waitcnt lgkmcnt(15)
  v_mfma_f32_16x16x32_bf16 v[0:3], a[64:67], a[128:131], 0
  ds_read_b64_tr_b16 a[0:1], v238 offset:9216
  v_mfma_f32_16x16x32_bf16 v[4:7], a[64:67], a[132:135], 0
  ds_read_b64_tr_b16 a[2:3], v238 offset:13824
  s_waitcnt lgkmcnt(15)
  v_mfma_f32_16x16x32_bf16 v[8:11], a[68:71], a[128:131], 0
  ds_read_b64_tr_b16 a[4:5], v238 offset:9248
  v_mfma_f32_16x16x32_bf16 v[12:15], a[68:71], a[132:135], 0
  ds_read_b64_tr_b16 a[6:7], v238 offset:13856
  s_waitcnt lgkmcnt(3)
  v_mfma_f32_16x16x32_bf16 v[16:19], a[72:75], a[128:131], 0
  ds_read_b64_tr_b16 a[8:9], v238 offset:9280
  v_mfma_f32_16x16x32_bf16 v[20:23], a[72:75], a[132:135], 0
  ds_read_b64_tr_b16 a[10:11], v238 offset:13888
  v_mfma_f32_16x16x32_bf16 v[24:27], a[76:79], a[128:131], 0
  ds_read_b64_tr_b16 a[12:13], v238 offset:9312
  v_mfma_f32_16x16x32_bf16 v[28:31], a[76:79], a[132:135], 0
  ds_read_b64_tr_b16 a[14:15], v238 offset:13920
  v_mfma_f32_16x16x32_bf16 v[32:35], a[80:83], a[128:131], 0
  ds_read_b64_tr_b16 a[16:17], v238 offset:9344
  v_mfma_f32_16x16x32_bf16 v[36:39], a[80:83], a[132:135], 0
  ds_read_b64_tr_b16 a[18:19], v238 offset:13952
  v_mfma_f32_16x16x32_bf16 v[40:43], a[84:87], a[128:131], 0
  ds_read_b64_tr_b16 a[20:21], v238 offset:9376
  v_mfma_f32_16x16x32_bf16 v[44:47], a[84:87], a[132:135], 0
  ds_read_b64_tr_b16 a[22:23], v238 offset:13984
  v_mfma_f32_16x16x32_bf16 v[48:51], a[88:91], a[128:131], 0
  ds_read_b64_tr_b16 a[24:25], v238 offset:9408
  v_mfma_f32_16x16x32_bf16 v[52:55], a[88:91], a[132:135], 0
  ds_read_b64_tr_b16 a[26:27], v238 offset:14016
  v_mfma_f32_16x16x32_bf16 v[56:59], a[92:95], a[128:131], 0
  ds_read_b64_tr_b16 a[28:29], v238 offset:9440
  v_mfma_f32_16x16x32_bf16 v[60:63], a[92:95], a[132:135], 0
  ds_read_b64_tr_b16 a[30:31], v238 offset:14048
  ds_read_b64_tr_b16 a[32:33], v238 offset:9472
  ds_read_b64_tr_b16 a[34:35], v238 offset:14080
  v_mfma_f32_16x16x32_bf16 v[64:67], a[96:99], a[128:131], 0
  v_mfma_f32_16x16x32_bf16 v[68:71], a[96:99], a[132:135], 0
  s_waitcnt lgkmcnt(3)
  v_mfma_f32_16x16x32_bf16 v[0:3], a[0:3], a[136:139], v[0:3]
  ds_read_b64_tr_b16 a[64:65], v238 offset:18432
  v_mfma_f32_16x16x32_bf16 v[4:7], a[0:3], a[140:143], v[4:7]
  ds_read_b64_tr_b16 a[66:67], v238 offset:23040
  v_mfma_f32_16x16x32_bf16 v[8:11], a[4:7], a[136:139], v[8:11]
  ds_read_b64_tr_b16 a[68:69], v238 offset:18464
  v_mfma_f32_16x16x32_bf16 v[12:15], a[4:7], a[140:143], v[12:15]
  ds_read_b64_tr_b16 a[70:71], v238 offset:23072
  v_mfma_f32_16x16x32_bf16 v[16:19], a[8:11], a[136:139], v[16:19]
  ds_read_b64_tr_b16 a[72:73], v238 offset:18496
  v_mfma_f32_16x16x32_bf16 v[20:23], a[8:11], a[140:143], v[20:23]
  ds_read_b64_tr_b16 a[74:75], v238 offset:23104
  v_mfma_f32_16x16x32_bf16 v[24:27], a[12:15], a[136:139], v[24:27]
  ds_read_b64_tr_b16 a[76:77], v238 offset:18528
  v_mfma_f32_16x16x32_bf16 v[28:31], a[12:15], a[140:143], v[28:31]
  ds_read_b64_tr_b16 a[78:79], v238 offset:23136
  v_mfma_f32_16x16x32_bf16 v[32:35], a[16:19], a[136:139], v[32:35]
  ds_read_b64_tr_b16 a[80:81], v238 offset:18560
  v_mfma_f32_16x16x32_bf16 v[36:39], a[16:19], a[140:143], v[36:39]
  ds_read_b64_tr_b16 a[82:83], v238 offset:23168
  v_mfma_f32_16x16x32_bf16 v[40:43], a[20:23], a[136:139], v[40:43]
  ds_read_b64_tr_b16 a[84:85], v238 offset:18592
  v_mfma_f32_16x16x32_bf16 v[44:47], a[20:23], a[140:143], v[44:47]
  ds_read_b64_tr_b16 a[86:87], v238 offset:23200
  v_mfma_f32_16x16x32_bf16 v[48:51], a[24:27], a[136:139], v[48:51]
  ds_read_b64_tr_b16 a[88:89], v238 offset:18624
  v_mfma_f32_16x16x32_bf16 v[52:55], a[24:27], a[140:143], v[52:55]
  ds_read_b64_tr_b16 a[90:91], v238 offset:23232
  s_waitcnt lgkmcnt(3)
  v_mfma_f32_16x16x32_bf16 v[56:59], a[28:31], a[136:139], v[56:59]
  ds_read_b64_tr_b16 a[92:93], v238 offset:18656
  v_mfma_f32_16x16x32_bf16 v[60:63], a[28:31], a[140:143], v[60:63]
  ds_read_b64_tr_b16 a[94:95], v238 offset:23264
  ds_read_b64_tr_b16 a[96:97], v238 offset:18688
  ds_read_b64_tr_b16 a[98:99], v238 offset:23296
  v_mfma_f32_16x16x32_bf16 v[64:67], a[32:35], a[136:139], v[64:67]
  v_mfma_f32_16x16x32_bf16 v[68:71], a[32:35], a[140:143], v[68:71]
  v_mfma_f32_16x16x32_bf16 v[0:3], a[64:67], a[144:147], v[0:3]
  ds_read_b64_tr_b16 a[0:1], v238 offset:27648
  v_mfma_f32_16x16x32_bf16 v[4:7], a[64:67], a[148:151], v[4:7]
  ds_read_b64_tr_b16 a[2:3], v238 offset:32256
  v_mfma_f32_16x16x32_bf16 v[8:11], a[68:71], a[144:147], v[8:11]
  ds_read_b64_tr_b16 a[4:5], v238 offset:27680
  v_mfma_f32_16x16x32_bf16 v[12:15], a[68:71], a[148:151], v[12:15]
  ds_read_b64_tr_b16 a[6:7], v238 offset:32288
  v_mfma_f32_16x16x32_bf16 v[16:19], a[72:75], a[144:147], v[16:19]
  ds_read_b64_tr_b16 a[8:9], v238 offset:27712
  v_mfma_f32_16x16x32_bf16 v[20:23], a[72:75], a[148:151], v[20:23]
  ds_read_b64_tr_b16 a[10:11], v238 offset:32320
  v_mfma_f32_16x16x32_bf16 v[24:27], a[76:79], a[144:147], v[24:27]
  ds_read_b64_tr_b16 a[12:13], v238 offset:27744
  v_mfma_f32_16x16x32_bf16 v[28:31], a[76:79], a[148:151], v[28:31]
  ds_read_b64_tr_b16 a[14:15], v238 offset:32352
  v_mfma_f32_16x16x32_bf16 v[32:35], a[80:83], a[144:147], v[32:35]
  ds_read_b64_tr_b16 a[16:17], v238 offset:27776
  v_mfma_f32_16x16x32_bf16 v[36:39], a[80:83], a[148:151], v[36:39]
  ds_read_b64_tr_b16 a[18:19], v238 offset:32384
  s_waitcnt lgkmcnt(3)
  v_mfma_f32_16x16x32_bf16 v[40:43], a[84:87], a[144:147], v[40:43]
  ds_read_b64_tr_b16 a[20:21], v238 offset:27808
  v_mfma_f32_16x16x32_bf16 v[44:47], a[84:87], a[148:151], v[44:47]
  ds_read_b64_tr_b16 a[22:23], v238 offset:32416
  v_mfma_f32_16x16x32_bf16 v[48:51], a[88:91], a[144:147], v[48:51]
  ds_read_b64_tr_b16 a[24:25], v238 offset:27840
  v_mfma_f32_16x16x32_bf16 v[52:55], a[88:91], a[148:151], v[52:55]
  ds_read_b64_tr_b16 a[26:27], v238 offset:32448
  v_mfma_f32_16x16x32_bf16 v[56:59], a[92:95], a[144:147], v[56:59]
  ds_read_b64_tr_b16 a[28:29], v238 offset:27872
  v_mfma_f32_16x16x32_bf16 v[60:63], a[92:95], a[148:151], v[60:63]
  ds_read_b64_tr_b16 a[30:31], v238 offset:32480
  ds_read_b64_tr_b16 a[32:33], v238 offset:27904
  ds_read_b64_tr_b16 a[34:35], v238 offset:32512
  v_mfma_f32_16x16x32_bf16 v[64:67], a[96:99], a[144:147], v[64:67]
  v_mfma_f32_16x16x32_bf16 v[68:71], a[96:99], a[148:151], v[68:71]
  s_waitcnt vmcnt(34) lgkmcnt(0)
  s_barrier
  v_mfma_f32_16x16x32_bf16 v[0:3], a[0:3], a[152:155], v[0:3]
  ds_read_b64_tr_b16 a[64:65], v239 offset:0
  v_mfma_f32_16x16x32_bf16 v[4:7], a[0:3], a[156:159], v[4:7]
  ds_read_b64_tr_b16 a[66:67], v239 offset:4608
  v_mfma_f32_16x16x32_bf16 v[8:11], a[4:7], a[152:155], v[8:11]
  ds_read_b64_tr_b16 a[68:69], v239 offset:32
  v_mfma_f32_16x16x32_bf16 v[12:15], a[4:7], a[156:159], v[12:15]
  ds_read_b64_tr_b16 a[70:71], v239 offset:4640
  v_mfma_f32_16x16x32_bf16 v[16:19], a[8:11], a[152:155], v[16:19]
  ds_read_b64_tr_b16 a[72:73], v239 offset:64
  v_mfma_f32_16x16x32_bf16 v[20:23], a[8:11], a[156:159], v[20:23]
  ds_read_b64_tr_b16 a[74:75], v239 offset:4672
  v_mfma_f32_16x16x32_bf16 v[24:27], a[12:15], a[152:155], v[24:27]
  ds_read_b64_tr_b16 a[76:77], v239 offset:96
  v_mfma_f32_16x16x32_bf16 v[28:31], a[12:15], a[156:159], v[28:31]
  ds_read_b64_tr_b16 a[78:79], v239 offset:4704
  v_mfma_f32_16x16x32_bf16 v[32:35], a[16:19], a[152:155], v[32:35]
  ds_read_b64_tr_b16 a[80:81], v239 offset:128
  v_mfma_f32_16x16x32_bf16 v[36:39], a[16:19], a[156:159], v[36:39]
  ds_read_b64_tr_b16 a[82:83], v239 offset:4736
  v_mfma_f32_16x16x32_bf16 v[40:43], a[20:23], a[152:155], v[40:43]
  ds_read_b64_tr_b16 a[84:85], v239 offset:160
  v_mfma_f32_16x16x32_bf16 v[44:47], a[20:23], a[156:159], v[44:47]
  ds_read_b64_tr_b16 a[86:87], v239 offset:4768
  v_mfma_f32_16x16x32_bf16 v[48:51], a[24:27], a[152:155], v[48:51]
  ds_read_b64_tr_b16 a[88:89], v239 offset:192
  v_mfma_f32_16x16x32_bf16 v[52:55], a[24:27], a[156:159], v[52:55]
  ds_read_b64_tr_b16 a[90:91], v239 offset:4800
  v_mfma_f32_16x16x32_bf16 v[56:59], a[28:31], a[152:155], v[56:59]
  ds_read_b64_tr_b16 a[92:93], v239 offset:224
  v_mfma_f32_16x16x32_bf16 v[60:63], a[28:31], a[156:159], v[60:63]
  ds_read_b64_tr_b16 a[94:95], v239 offset:4832
  ds_read_b64_tr_b16 a[96:97], v239 offset:256
  ds_read_b64_tr_b16 a[98:99], v239 offset:4864
  v_mfma_f32_16x16x32_bf16 v[64:67], a[32:35], a[152:155], v[64:67]
  v_mfma_f32_16x16x32_bf16 v[68:71], a[32:35], a[156:159], v[68:71]
  s_add_u32 s72, s6, 0
  s_sub_u32 s73, s72, 7
  s_cmp_ge_u32 s72, 7
  s_cselect_b32 s72, s73, s72
  s_add_u32 s72, s72, s56
  s_add_u32 s72, s72, 1
  s_and_b32 s72, s72, 7
  s_lshl_b32 s73, s55, 3
  s_add_u32 s73, s72, s73
  s_lshl_b32 s73, s73, 16
  s_add_u32 s21, s73, s77
  s_add_u32 s72, s6, 1
  s_sub_u32 s73, s72, 7
  s_cmp_ge_u32 s72, 7
  s_cselect_b32 s72, s73, s72
  s_add_u32 s72, s72, s56
  s_add_u32 s72, s72, 1
  s_and_b32 s72, s72, 7
  s_lshl_b32 s73, s55, 3
  s_add_u32 s73, s72, s73
  s_lshl_b32 s73, s73, 16
  s_add_u32 s22, s73, s77
  s_add_u32 s72, s6, 2
  s_sub_u32 s73, s72, 7
  s_cmp_ge_u32 s72, 7
  s_cselect_b32 s72, s73, s72
  s_add_u32 s72, s72, s56
  s_add_u32 s72, s72, 1
  s_and_b32 s72, s72, 7
  s_lshl_b32 s73, s55, 3
  s_add_u32 s73, s72, s73
  s_lshl_b32 s73, s73, 16
  s_add_u32 s23, s73, s77
  s_add_u32 s72, s6, 3
  s_sub_u32 s73, s72, 7
  s_cmp_ge_u32 s72, 7
  s_cselect_b32 s72, s73, s72
  s_add_u32 s72, s72, s56
  s_add_u32 s72, s72, 1
  s_and_b32 s72, s72, 7
  s_lshl_b32 s73, s55, 3
  s_add_u32 s73, s72, s73
  s_lshl_b32 s73, s73, 16
  s_add_u32 s24, s73, s77
  s_mul_i32 s72, s72, 147456
  s_add_u32 s28, s72, s76
  s_add_u32 s72, s6, 4
  s_sub_u32 s73, s72, 7
  s_cmp_ge_u32 s72, 7
  s_cselect_b32 s72, s73, s72
  s_add_u32 s72, s72, s56
  s_add_u32 s72, s72, 1
  s_and_b32 s72, s72, 7
  s_lshl_b32 s73, s55, 3
  s_add_u32 s73, s72, s73
  s_lshl_b32 s73, s73, 16
  s_add_u32 s25, s73, s77
  s_mul_i32 s72, s72, 147456
  s_add_u32 s29, s72, s76
  s_add_u32 s72, s6, 5
  s_sub_u32 s73, s72, 7
  s_cmp_ge_u32 s72, 7
  s_cselect_b32 s72, s73, s72
  s_add_u32 s72, s72, s56
  s_add_u32 s72, s72, 1
  s_and_b32 s72, s72, 7
  s_lshl_b32 s73, s55, 3
  s_add_u32 s73, s72, s73
  s_lshl_b32 s73, s73, 16
  s_add_u32 s26, s73, s77
  s_mul_i32 s72, s72, 147456
  s_add_u32 s30, s72, s76
  s_add_u32 s72, s6, 6
  s_sub_u32 s73, s72, 7
  s_cmp_ge_u32 s72, 7
  s_cselect_b32 s72, s73, s72
  s_add_u32 s72, s72, s56
  s_add_u32 s72, s72, 1
  s_and_b32 s72, s72, 7
  s_lshl_b32 s73, s55, 3
  s_add_u32 s73, s72, s73
  s_lshl_b32 s73, s73, 16
  s_add_u32 s27, s73, s77
  s_mul_i32 s72, s72, 147456
  s_add_u32 s31, s72, s76
  s_mul_i32 s5, s54, 9216
  s_lshl_b32 s70, s55, 2
  s_add_u32 s70, s70, s54
  s_mul_i32 s70, s70, 18432
  s_mov_b32 s71, 0x10000000
  s_cmp_eq_u32 s55, 0
  s_cselect_b32 s32, s71, s70
  s_cmp_eq_u32 s55, 1
  s_cselect_b32 s33, s71, s70
  s_cmp_eq_u32 s55, 2
  s_cselect_b32 s34, s71, s70
  s_cmp_eq_u32 s55, 3
  s_cselect_b32 s35, s71, s70
  s_waitcnt vmcnt(0)
  s_mov_b32 s72, 0
L_non:
  v_or_b32 v244, v232, v233
  v_cmp_ne_u32 vcc, 0, v244
  s_cmp_lg_u64 vcc, 0
  s_cbranch_scc1 L_non_ok
  global_load_dwordx2 v[232:233], v231, s[16:17] sc1
  s_waitcnt vmcnt(0)
  s_add_u32 s72, s72, 1
  s_cmp_lt_u32 s72, 0x40000
  s_cbranch_scc1 L_non
L_non_ok:
  s_lshl_b32 s73, 1, s56
  s_mov_b64 exec, 0xff
  global_load_dwordx2 v[244:245], v235, s[18:19] sc1
  s_mov_b64 exec, 1
  global_store_dwordx2 v234, v[232:233], s[18:19] sc1
  s_mov_b64 exec, 0xff
  s_waitcnt vmcnt(1)
  v_cmp_eq_u32 vcc, v244, v232
  v_cmp_eq_u32 s[70:71], v245, v233
  s_and_b64 vcc, vcc, s[70:71]
  s_or_b32 s70, vcc_lo, s73
  s_cmp_eq_u32 s70, 255
  s_cbranch_scc1 L_o_ok
  s_mov_b32 s72, 0
  global_load_dwordx2 v[244:245], v235, s[18:19] sc1
L_o_poll:
  global_load_dwordx2 v[246:247], v235, s[18:19] sc1
  s_waitcnt vmcnt(1)
  v_cmp_eq_u32 vcc, v244, v232
  v_cmp_eq_u32 s[70:71], v245, v233
  s_and_b64 vcc, vcc, s[70:71]
  s_or_b32 s70, vcc_lo, s73
  s_cmp_eq_u32 s70, 255
  s_cbranch_scc1 L_o_ok
  global_load_dwordx2 v[244:245], v235, s[18:19] sc1
  s_waitcnt vmcnt(1)
  v_cmp_eq_u32 vcc, v246, v232
  v_cmp_eq_u32 s[70:71], v247, v233
  s_and_b64 vcc, vcc, s[70:71]
  s_or_b32 s70, vcc_lo, s73
  s_cmp_eq_u32 s70, 255
  s_cbranch_scc1 L_o_ok
  s_add_u32 s72, s72, 1
  s_cmp_lt_u32 s72, 0x40000
  s_cbranch_scc1 L_o_poll
L_o_ok:
  s_mov_b64 exec, -1
  buffer_load_dwordx4 a[160:163], v208, s[40:43], s21 offen offset:0 sc1
  buffer_load_dwordx4 a[164:167], v236, s[40:43], s21 offen offset:0 sc1
  buffer_load_dwordx4 a[168:171], v208, s[40:43], s21 offen offset:1024 sc1
  buffer_load_dwordx4 a[172:175], v236, s[40:43], s21 offen offset:1024 sc1
  buffer_load_dwordx4 a[176:179], v208, s[40:43], s21 offen offset:2048 sc1
  buffer_load_dwordx4 a[180:183], v236, s[40:43], s21 offen offset:2048 sc1
  buffer_load_dwordx4 a[184:187], v208, s[40:43], s21 offen offset:3072 sc1
  buffer_load_dwordx4 a[188:191], v236, s[40:43], s21 offen offset:3072 sc1
  s_waitcnt vmcnt(6)
  s_waitcnt lgkmcnt(3)
  v_mfma_f32_16x16x32_bf16 v[0:3], a[64:67], a[160:163], v[0:3]
  ds_read_b64_tr_b16 a[0:1], v239 offset:9216
  v_mfma_f32_16x16x32_bf16 v[4:7], a[64:67], a[164:167], v[4:7]
  ds_read_b64_tr_b16 a[2:3], v239 offset:13824
  v_mfma_f32_16x16x32_bf16 v[8:11], a[68:71], a[160:163], v[8:11]
  ds_read_b64_tr_b16 a[4:5], v239 offset:9248
  buffer_load_dwordx4 a[192:195], v208, s[40:43], s22 offen offset:0 sc1
  v_mfma_f32_16x16x32_bf16 v[12:15], a[68:71], a[164:167], v[12:15]
  ds_read_b64_tr_b16 a[6:7], v239 offset:13856
  v_mfma_f32_16x16x32_bf16 v[16:19], a[72:75], a[160:163], v[16:19]
  ds_read_b64_tr_b16 a[8:9], v239 offset:9280
  v_mfma_f32_16x16x32_bf16 v[20:23], a[72:75], a[164:167], v[20:23]
  ds_read_b64_tr_b16 a[10:11], v239 offset:13888
  v_mfma_f32_16x16x32_bf16 v[24:27], a[76:79], a[160:163], v[24:27]
  ds_read_b64_tr_b16 a[12:13], v239 offset:9312
  buffer_load_dwordx4 a[196:199], v236, s[40:43], s22 offen offset:0 sc1
  v_mfma_f32_16x16x32_bf16 v[28:31], a[76:79], a[164:167], v[28:31]
  ds_read_b64_tr_b16 a[14:15], v239 offset:13920
  v_mfma_f32_16x16x32_bf16 v[32:35], a[80:83], a[160:163], v[32:35]
  ds_read_b64_tr_b16 a[16:17], v239 offset:9344
  v_mfma_f32_16x16x32_bf16 v[36:39], a[80:83], a[164:167], v[36:39]
  ds_read_b64_tr_b16 a[18:19], v239 offset:13952
  v_mfma_f32_16x16x32_bf16 v[40:43], a[84:87], a[160:163], v[40:43]
  ds_read_b64_tr_b16 a[20:21], v239 offset:9376
  buffer_load_dwordx4 a[200:203], v208, s[40:43], s22 offen offset:1024 sc1
  v_mfma_f32_16x16x32_bf16 v[44:47], a[84:87], a[164:167], v[44:47]
  ds_read_b64_tr_b16 a[22:23], v239 offset:13984
  v_mfma_f32_16x16x32_bf16 v[48:51], a[88:91], a[160:163], v[48:51]
  ds_read_b64_tr_b16 a[24:25], v239 offset:9408
  v_mfma_f32_16x16x32_bf16 v[52:55], a[88:91], a[164:167], v[52:55]
  ds_read_b64_tr_b16 a[26:27], v239 offset:14016
  s_waitcnt lgkmcnt(3)
  v_mfma_f32_16x16x32_bf16 v[56:59], a[92:95], a[160:163], v[56:59]
  ds_read_b64_tr_b16 a[28:29], v239 offset:9440
  buffer_load_dwordx4 a[204:207], v236, s[40:43], s22 offen offset:1024 sc1
  v_mfma_f32_16x16x32_bf16 v[60:63], a[92:95], a[164:167], v[60:63]
  ds_read_b64_tr_b16 a[30:31], v239 offset:14048
  ds_read_b64_tr_b16 a[32:33], v239 offset:9472
  ds_read_b64_tr_b16 a[34:35], v239 offset:14080
  v_mfma_f32_16x16x32_bf16 v[64:67], a[96:99], a[160:163], v[64:67]
  v_mfma_f32_16x16x32_bf16 v[68:71], a[96:99], a[164:167], v[68:71]
  s_waitcnt vmcnt(8)
  v_mfma_f32_16x16x32_bf16 v[0:3], a[0:3], a[168:171], v[0:3]
  ds_read_b64_tr_b16 a[64:65], v239 offset:18432
  v_mfma_f32_16x16x32_bf16 v[4:7], a[0:3], a[172:175], v[4:7]
  ds_read_b64_tr_b16 a[66:67], v239 offset:23040
  v_mfma_f32_16x16x32_bf16 v[8:11], a[4:7], a[168:171], v[8:11]
  ds_read_b64_tr_b16 a[68:69], v239 offset:18464
  buffer_load_dwordx4 a[208:211], v208, s[40:43], s22 offen offset:2048 sc1
  v_mfma_f32_16x16x32_bf16 v[12:15], a[4:7], a[172:175], v[12:15]
  ds_read_b64_tr_b16 a[70:71], v239 offset:23072
  v_mfma_f32_16x16x32_bf16 v[16:19], a[8:11], a[168:171], v[16:19]
  ds_read_b64_tr_b16 a[72:73], v239 offset:18496
  v_mfma_f32_16x16x32_bf16 v[20:23], a[8:11], a[172:175], v[20:23]
  ds_read_b64_tr_b16 a[74:75], v239 offset:23104
  v_mfma_f32_16x16x32_bf16 v[24:27], a[12:15], a[168:171], v[24:27]
  ds_read_b64_tr_b16 a[76:77], v239 offset:18528
  buffer_load_dwordx4 a[212:215], v236, s[40:43], s22 offen offset:2048 sc1
  v_mfma_f32_16x16x32_bf16 v[28:31], a[12:15], a[172:175], v[28:31]
  ds_read_b64_tr_b16 a[78:79], v239 offset:23136
  v_mfma_f32_16x16x32_bf16 v[32:35], a[16:19], a[168:171], v[32:35]
  ds_read_b64_tr_b16 a[80:81], v239 offset:18560
  v_mfma_f32_16x16x32_bf16 v[36:39], a[16:19], a[172:175], v[36:39]
  ds_read_b64_tr_b16 a[82:83], v239 offset:23168
  s_waitcnt lgkmcnt(3)
  v_mfma_f32_16x16x32_bf16 v[40:43], a[20:23], a[168:171], v[40:43]
  ds_read_b64_tr_b16 a[84:85], v239 offset:18592
  buffer_load_dwordx4 a[216:219], v208, s[40:43], s22 offen offset:3072 sc1
  v_mfma_f32_16x16x32_bf16 v[44:47], a[20:23], a[172:175], v[44:47]
  ds_read_b64_tr_b16 a[86:87], v239 offset:23200
  v_mfma_f32_16x16x32_bf16 v[48:51], a[24:27], a[168:171], v[48:51]
  ds_read_b64_tr_b16 a[88:89], v239 offset:18624
  v_mfma_f32_16x16x32_bf16 v[52:55], a[24:27], a[172:175], v[52:55]
  ds_read_b64_tr_b16 a[90:91], v239 offset:23232
  v_mfma_f32_16x16x32_bf16 v[56:59], a[28:31], a[168:171], v[56:59]
  ds_read_b64_tr_b16 a[92:93], v239 offset:18656
  buffer_load_dwordx4 a[220:223], v236, s[40:43], s22 offen offset:3072 sc1
  v_mfma_f32_16x16x32_bf16 v[60:63], a[28:31], a[172:175], v[60:63]
  ds_read_b64_tr_b16 a[94:95], v239 offset:23264
  ds_read_b64_tr_b16 a[96:97], v239 offset:18688
  ds_read_b64_tr_b16 a[98:99], v239 offset:23296
  v_mfma_f32_16x16x32_bf16 v[64:67], a[32:35], a[168:171], v[64:67]
  v_mfma_f32_16x16x32_bf16 v[68:71], a[32:35], a[172:175], v[68:71]
  s_waitcnt vmcnt(10)
  v_mfma_f32_16x16x32_bf16 v[0:3], a[64:67], a[176:179], v[0:3]
  ds_read_b64_tr_b16 a[0:1], v239 offset:27648
  v_mfma_f32_16x16x32_bf16 v[4:7], a[64:67], a[180:183], v[4:7]
  ds_read_b64_tr_b16 a[2:3], v239 offset:32256
  v_mfma_f32_16x16x32_bf16 v[8:11], a[68:71], a[176:179], v[8:11]
  ds_read_b64_tr_b16 a[4:5], v239 offset:27680
  buffer_load_dwordx4 a[224:227], v208, s[40:43], s23 offen offset:0 sc1
  v_mfma_f32_16x16x32_bf16 v[12:15], a[68:71], a[180:183], v[12:15]
  ds_read_b64_tr_b16 a[6:7], v239 offset:32288
  v_mfma_f32_16x16x32_bf16 v[16:19], a[72:75], a[176:179], v[16:19]
  ds_read_b64_tr_b16 a[8:9], v239 offset:27712
  v_mfma_f32_16x16x32_bf16 v[20:23], a[72:75], a[180:183], v[20:23]
  ds_read_b64_tr_b16 a[10:11], v239 offset:32320
  s_waitcnt lgkmcnt(3)
  v_mfma_f32_16x16x32_bf16 v[24:27], a[76:79], a[176:179], v[24:27]
  ds_read_b64_tr_b16 a[12:13], v239 offset:27744
  buffer_load_dwordx4 a[228:231], v236, s[40:43], s23 offen offset:0 sc1
  v_mfma_f32_16x16x32_bf16 v[28:31], a[76:79], a[180:183], v[28:31]
  ds_read_b64_tr_b16 a[14:15], v239 offset:32352
  v_mfma_f32_16x16x32_bf16 v[32:35], a[80:83], a[176:179], v[32:35]
  ds_read_b64_tr_b16 a[16:17], v239 offset:27776
  v_mfma_f32_16x16x32_bf16 v[36:39], a[80:83], a[180:183], v[36:39]
  ds_read_b64_tr_b16 a[18:19], v239 offset:32384
  v_mfma_f32_16x16x32_bf16 v[40:43], a[84:87], a[176:179], v[40:43]
  ds_read_b64_tr_b16 a[20:21], v239 offset:27808
  buffer_load_dwordx4 a[232:235], v208, s[40:43], s23 offen offset:1024 sc1
  v_mfma_f32_16x16x32_bf16 v[44:47], a[84:87], a[180:183], v[44:47]
  ds_read_b64_tr_b16 a[22:23], v239 offset:32416
  v_mfma_f32_16x16x32_bf16 v[48:51], a[88:91], a[176:179], v[48:51]
  ds_read_b64_tr_b16 a[24:25], v239 offset:27840
  v_mfma_f32_16x16x32_bf16 v[52:55], a[88:91], a[180:183], v[52:55]
  ds_read_b64_tr_b16 a[26:27], v239 offset:32448
  v_mfma_f32_16x16x32_bf16 v[56:59], a[92:95], a[176:179], v[56:59]
  ds_read_b64_tr_b16 a[28:29], v239 offset:27872
  buffer_load_dwordx4 a[236:239], v236, s[40:43], s23 offen offset:1024 sc1
  v_mfma_f32_16x16x32_bf16 v[60:63], a[92:95], a[180:183], v[60:63]
  ds_read_b64_tr_b16 a[30:31], v239 offset:32480
  ds_read_b64_tr_b16 a[32:33], v239 offset:27904
  ds_read_b64_tr_b16 a[34:35], v239 offset:32512
  v_mfma_f32_16x16x32_bf16 v[64:67], a[96:99], a[176:179], v[64:67]
  v_mfma_f32_16x16x32_bf16 v[68:71], a[96:99], a[180:183], v[68:71]
  s_waitcnt vmcnt(12)
  s_waitcnt vmcnt(45) lgkmcnt(0)
  s_barrier
  v_mfma_f32_16x16x32_bf16 v[0:3], a[0:3], a[184:187], v[0:3]
  ds_read_b64_tr_b16 a[64:65], v240 offset:0
  v_mfma_f32_16x16x32_bf16 v[4:7], a[0:3], a[188:191], v[4:7]
  ds_read_b64_tr_b16 a[66:67], v240 offset:4608
  v_mfma_f32_16x16x32_bf16 v[8:11], a[4:7], a[184:187], v[8:11]
  ds_read_b64_tr_b16 a[68:69], v240 offset:32
  buffer_load_dwordx4 a[240:243], v208, s[40:43], s23 offen offset:2048 sc1
  v_mfma_f32_16x16x32_bf16 v[12:15], a[4:7], a[188:191], v[12:15]
  ds_read_b64_tr_b16 a[70:71], v240 offset:4640
  v_mfma_f32_16x16x32_bf16 v[16:19], a[8:11], a[184:187], v[16:19]
  ds_read_b64_tr_b16 a[72:73], v240 offset:64
  v_mfma_f32_16x16x32_bf16 v[20:23], a[8:11], a[188:191], v[20:23]
  ds_read_b64_tr_b16 a[74:75], v240 offset:4672
  v_mfma_f32_16x16x32_bf16 v[24:27], a[12:15], a[184:187], v[24:27]
  ds_read_b64_tr_b16 a[76:77], v240 offset:96
  buffer_load_dwordx4 a[244:247], v236, s[40:43], s23 offen offset:2048 sc1
  v_mfma_f32_16x16x32_bf16 v[28:31], a[12:15], a[188:191], v[28:31]
  ds_read_b64_tr_b16 a[78:79], v240 offset:4704
  v_mfma_f32_16x16x32_bf16 v[32:35], a[16:19], a[184:187], v[32:35]
  ds_read_b64_tr_b16 a[80:81], v240 offset:128
  v_mfma_f32_16x16x32_bf16 v[36:39], a[16:19], a[188:191], v[36:39]
  ds_read_b64_tr_b16 a[82:83], v240 offset:4736
  v_mfma_f32_16x16x32_bf16 v[40:43], a[20:23], a[184:187], v[40:43]
  ds_read_b64_tr_b16 a[84:85], v240 offset:160
  buffer_load_dwordx4 a[248:251], v208, s[40:43], s23 offen offset:3072 sc1
  v_mfma_f32_16x16x32_bf16 v[44:47], a[20:23], a[188:191], v[44:47]
  ds_read_b64_tr_b16 a[86:87], v240 offset:4768
  v_mfma_f32_16x16x32_bf16 v[48:51], a[24:27], a[184:187], v[48:51]
  ds_read_b64_tr_b16 a[88:89], v240 offset:192
  v_mfma_f32_16x16x32_bf16 v[52:55], a[24:27], a[188:191], v[52:55]
  ds_read_b64_tr_b16 a[90:91], v240 offset:4800
  v_mfma_f32_16x16x32_bf16 v[56:59], a[28:31], a[184:187], v[56:59]
  ds_read_b64_tr_b16 a[92:93], v240 offset:224
  buffer_load_dwordx4 a[252:255], v236, s[40:43], s23 offen offset:3072 sc1
  v_mfma_f32_16x16x32_bf16 v[60:63], a[28:31], a[188:191], v[60:63]
  ds_read_b64_tr_b16 a[94:95], v240 offset:4832
  ds_read_b64_tr_b16 a[96:97], v240 offset:256
  ds_read_b64_tr_b16 a[98:99], v240 offset:4864
  v_mfma_f32_16x16x32_bf16 v[64:67], a[32:35], a[184:187], v[64:67]
  v_mfma_f32_16x16x32_bf16 v[68:71], a[32:35], a[188:191], v[68:71]
  s_waitcnt vmcnt(14)
  s_waitcnt lgkmcnt(3)
  v_mfma_f32_16x16x32_bf16 v[0:3], a[64:67], a[192:195], v[0:3]
  ds_read_b64_tr_b16 a[0:1], v240 offset:9216
  v_mfma_f32_16x16x32_bf16 v[4:7], a[64:67], a[196:199], v[4:7]
  ds_read_b64_tr_b16 a[2:3], v240 offset:13824
  s_add_u32 m0, s5, 90112
  v_mfma_f32_16x16x32_bf16 v[8:11], a[68:71], a[192:195], v[8:11]
  ds_read_b64_tr_b16 a[4:5], v240 offset:9248
  buffer_load_dwordx4 v198, s[36:39], s28 offen offset:0  lds
  v_mfma_f32_16x16x32_bf16 v[12:15], a[68:71], a[196:199], v[12:15]
  ds_read_b64_tr_b16 a[6:7], v240 offset:13856
  v_mfma_f32_16x16x32_bf16 v[16:19], a[72:75], a[192:195], v[16:19]
  ds_read_b64_tr_b16 a[8:9], v240 offset:9280
  v_mfma_f32_16x16x32_bf16 v[20:23], a[72:75], a[196:199], v[20:23]
  ds_read_b64_tr_b16 a[10:11], v240 offset:13888
  s_add_u32 m0, s5, 90112
  v_mfma_f32_16x16x32_bf16 v[24:27], a[76:79], a[192:195], v[24:27]
  ds_read_b64_tr_b16 a[12:13], v240 offset:9312
  buffer_load_dwordx4 v199, s[36:39], s28 offen offset:1024  lds
  v_mfma_f32_16x16x32_bf16 v[28:31], a[76:79], a[196:199], v[28:31]
  ds_read_b64_tr_b16 a[14:15], v240 offset:13920
  v_mfma_f32_16x16x32_bf16 v[32:35], a[80:83], a[192:195], v[32:35]
  ds_read_b64_tr_b16 a[16:17], v240 offset:9344
  v_mfma_f32_16x16x32_bf16 v[36:39], a[80:83], a[196:199], v[36:39]
  ds_read_b64_tr_b16 a[18:19], v240 offset:13952
  s_add_u32 m0, s5, 90112
  v_mfma_f32_16x16x32_bf16 v[40:43], a[84:87], a[192:195], v[40:43]
  ds_read_b64_tr_b16 a[20:21], v240 offset:9376
  buffer_load_dwordx4 v200, s[36:39], s28 offen offset:2048  lds
  v_mfma_f32_16x16x32_bf16 v[44:47], a[84:87], a[196:199], v[44:47]
  ds_read_b64_tr_b16 a[22:23], v240 offset:13984
  v_mfma_f32_16x16x32_bf16 v[48:51], a[88:91], a[192:195], v[48:51]
  ds_read_b64_tr_b16 a[24:25], v240 offset:9408
  v_mfma_f32_16x16x32_bf16 v[52:55], a[88:91], a[196:199], v[52:55]
  ds_read_b64_tr_b16 a[26:27], v240 offset:14016
  s_add_u32 m0, s5, 93184
  s_waitcnt lgkmcnt(3)
  v_mfma_f32_16x16x32_bf16 v[56:59], a[92:95], a[192:195], v[56:59]
  ds_read_b64_tr_b16 a[28:29], v240 offset:9440
  buffer_load_dwordx4 v201, s[36:39], s28 offen offset:0  lds
  v_mfma_f32_16x16x32_bf16 v[60:63], a[92:95], a[196:199], v[60:63]
  ds_read_b64_tr_b16 a[30:31], v240 offset:14048
  ds_read_b64_tr_b16 a[32:33], v240 offset:9472
  ds_read_b64_tr_b16 a[34:35], v240 offset:14080
  v_mfma_f32_16x16x32_bf16 v[64:67], a[96:99], a[192:195], v[64:67]
  v_mfma_f32_16x16x32_bf16 v[68:71], a[96:99], a[196:199], v[68:71]
  s_waitcnt vmcnt(16)
  v_mfma_f32_16x16x32_bf16 v[0:3], a[0:3], a[200:203], v[0:3]
  ds_read_b64_tr_b16 a[64:65], v240 offset:18432
  v_mfma_f32_16x16x32_bf16 v[4:7], a[0:3], a[204:207], v[4:7]
  ds_read_b64_tr_b16 a[66:67], v240 offset:23040
  s_add_u32 m0, s5, 93184
  v_mfma_f32_16x16x32_bf16 v[8:11], a[4:7], a[200:203], v[8:11]
  ds_read_b64_tr_b16 a[68:69], v240 offset:18464
  buffer_load_dwordx4 v202, s[36:39], s28 offen offset:1024  lds
  v_mfma_f32_16x16x32_bf16 v[12:15], a[4:7], a[204:207], v[12:15]
  ds_read_b64_tr_b16 a[70:71], v240 offset:23072
  v_mfma_f32_16x16x32_bf16 v[16:19], a[8:11], a[200:203], v[16:19]
  ds_read_b64_tr_b16 a[72:73], v240 offset:18496
  v_mfma_f32_16x16x32_bf16 v[20:23], a[8:11], a[204:207], v[20:23]
  ds_read_b64_tr_b16 a[74:75], v240 offset:23104
  s_add_u32 m0, s5, 93184
  v_mfma_f32_16x16x32_bf16 v[24:27], a[12:15], a[200:203], v[24:27]
  ds_read_b64_tr_b16 a[76:77], v240 offset:18528
  buffer_load_dwordx4 v203, s[36:39], s28 offen offset:2048  lds
  v_mfma_f32_16x16x32_bf16 v[28:31], a[12:15], a[204:207], v[28:31]
  ds_read_b64_tr_b16 a[78:79], v240 offset:23136
  v_mfma_f32_16x16x32_bf16 v[32:35], a[16:19], a[200:203], v[32:35]
  ds_read_b64_tr_b16 a[80:81], v240 offset:18560
  v_mfma_f32_16x16x32_bf16 v[36:39], a[16:19], a[204:207], v[36:39]
  ds_read_b64_tr_b16 a[82:83], v240 offset:23168
  s_add_u32 m0, s5, 96256
  s_waitcnt lgkmcnt(3)
  v_mfma_f32_16x16x32_bf16 v[40:43], a[20:23], a[200:203], v[40:43]
  ds_read_b64_tr_b16 a[84:85], v240 offset:18592
  buffer_load_dwordx4 v204, s[36:39], s28 offen offset:0  lds
  v_mfma_f32_16x16x32_bf16 v[44:47], a[20:23], a[204:207], v[44:47]
  ds_read_b64_tr_b16 a[86:87], v240 offset:23200
  v_mfma_f32_16x16x32_bf16 v[48:51], a[24:27], a[200:203], v[48:51]
  ds_read_b64_tr_b16 a[88:89], v240 offset:18624
  v_mfma_f32_16x16x32_bf16 v[52:55], a[24:27], a[204:207], v[52:55]
  ds_read_b64_tr_b16 a[90:91], v240 offset:23232
  s_add_u32 m0, s5, 96256
  v_mfma_f32_16x16x32_bf16 v[56:59], a[28:31], a[200:203], v[56:59]
  ds_read_b64_tr_b16 a[92:93], v240 offset:18656
  buffer_load_dwordx4 v205, s[36:39], s28 offen offset:1024  lds
  v_mfma_f32_16x16x32_bf16 v[60:63], a[28:31], a[204:207], v[60:63]
  ds_read_b64_tr_b16 a[94:95], v240 offset:23264
  ds_read_b64_tr_b16 a[96:97], v240 offset:18688
  ds_read_b64_tr_b16 a[98:99], v240 offset:23296
  v_mfma_f32_16x16x32_bf16 v[64:67], a[32:35], a[200:203], v[64:67]
  v_mfma_f32_16x16x32_bf16 v[68:71], a[32:35], a[204:207], v[68:71]
  s_waitcnt vmcnt(18)
  v_mfma_f32_16x16x32_bf16 v[0:3], a[64:67], a[208:211], v[0:3]
  ds_read_b64_tr_b16 a[0:1], v240 offset:27648
  v_mfma_f32_16x16x32_bf16 v[4:7], a[64:67], a[212:215], v[4:7]
  ds_read_b64_tr_b16 a[2:3], v240 offset:32256
  s_add_u32 m0, s5, 96256
  v_mfma_f32_16x16x32_bf16 v[8:11], a[68:71], a[208:211], v[8:11]
  ds_read_b64_tr_b16 a[4:5], v240 offset:27680
  buffer_load_dwordx4 v206, s[36:39], s28 offen offset:2048  lds
  v_mfma_f32_16x16x32_bf16 v[12:15], a[68:71], a[212:215], v[12:15]
  ds_read_b64_tr_b16 a[6:7], v240 offset:32288
  v_mfma_f32_16x16x32_bf16 v[16:19], a[72:75], a[208:211], v[16:19]
  ds_read_b64_tr_b16 a[8:9], v240 offset:27712
  v_mfma_f32_16x16x32_bf16 v[20:23], a[72:75], a[212:215], v[20:23]
  ds_read_b64_tr_b16 a[10:11], v240 offset:32320
  s_waitcnt lgkmcnt(3)
  v_mfma_f32_16x16x32_bf16 v[24:27], a[76:79], a[208:211], v[24:27]
  ds_read_b64_tr_b16 a[12:13], v240 offset:27744
  buffer_load_dwordx4 a[128:131], v208, s[40:43], s24 offen offset:0 sc1
  v_mfma_f32_16x16x32_bf16 v[28:31], a[76:79], a[212:215], v[28:31]
  ds_read_b64_tr_b16 a[14:15], v240 offset:32352
  v_mfma_f32_16x16x32_bf16 v[32:35], a[80:83], a[208:211], v[32:35]
  ds_read_b64_tr_b16 a[16:17], v240 offset:27776
  v_mfma_f32_16x16x32_bf16 v[36:39], a[80:83], a[212:215], v[36:39]
  ds_read_b64_tr_b16 a[18:19], v240 offset:32384
  v_mfma_f32_16x16x32_bf16 v[40:43], a[84:87], a[208:211], v[40:43]
  ds_read_b64_tr_b16 a[20:21], v240 offset:27808
  buffer_load_dwordx4 a[132:135], v236, s[40:43], s24 offen offset:0 sc1
  v_mfma_f32_16x16x32_bf16 v[44:47], a[84:87], a[212:215], v[44:47]
  ds_read_b64_tr_b16 a[22:23], v240 offset:32416
  v_mfma_f32_16x16x32_bf16 v[48:51], a[88:91], a[208:211], v[48:51]
  ds_read_b64_tr_b16 a[24:25], v240 offset:27840
  v_mfma_f32_16x16x32_bf16 v[52:55], a[88:91], a[212:215], v[52:55]
  ds_read_b64_tr_b16 a[26:27], v240 offset:32448
  v_mfma_f32_16x16x32_bf16 v[56:59], a[92:95], a[208:211], v[56:59]
  ds_read_b64_tr_b16 a[28:29], v240 offset:27872
  buffer_load_dwordx4 a[136:139], v208, s[40:43], s24 offen offset:1024 sc1
  v_mfma_f32_16x16x32_bf16 v[60:63], a[92:95], a[212:215], v[60:63]
  ds_read_b64_tr_b16 a[30:31], v240 offset:32480
  ds_read_b64_tr_b16 a[32:33], v240 offset:27904
  ds_read_b64_tr_b16 a[34:35], v240 offset:32512
  v_mfma_f32_16x16x32_bf16 v[64:67], a[96:99], a[208:211], v[64:67]
  v_mfma_f32_16x16x32_bf16 v[68:71], a[96:99], a[212:215], v[68:71]
  s_waitcnt vmcnt(20)
  s_waitcnt vmcnt(44) lgkmcnt(0)
  s_barrier
  v_mfma_f32_16x16x32_bf16 v[0:3], a[0:3], a[216:219], v[0:3]
  ds_read_b64_tr_b16 a[64:65], v241 offset:0
  v_mfma_f32_16x16x32_bf16 v[4:7], a[0:3], a[220:223], v[4:7]
  ds_read_b64_tr_b16 a[66:67], v241 offset:4608
  v_mfma_f32_16x16x32_bf16 v[8:11], a[4:7], a[216:219], v[8:11]
  ds_read_b64_tr_b16 a[68:69], v241 offset:32
  buffer_load_dwordx4 a[140:143], v236, s[40:43], s24 offen offset:1024 sc1
  v_mfma_f32_16x16x32_bf16 v[12:15], a[4:7], a[220:223], v[12:15]
  ds_read_b64_tr_b16 a[70:71], v241 offset:4640
  v_mfma_f32_16x16x32_bf16 v[16:19], a[8:11], a[216:219], v[16:19]
  ds_read_b64_tr_b16 a[72:73], v241 offset:64
  v_mfma_f32_16x16x32_bf16 v[20:23], a[8:11], a[220:223], v[20:23]
  ds_read_b64_tr_b16 a[74:75], v241 offset:4672
  v_mfma_f32_16x16x32_bf16 v[24:27], a[12:15], a[216:219], v[24:27]
  ds_read_b64_tr_b16 a[76:77], v241 offset:96
  buffer_load_dwordx4 a[144:147], v208, s[40:43], s24 offen offset:2048 sc1
  v_mfma_f32_16x16x32_bf16 v[28:31], a[12:15], a[220:223], v[28:31]
  ds_read_b64_tr_b16 a[78:79], v241 offset:4704
  v_mfma_f32_16x16x32_bf16 v[32:35], a[16:19], a[216:219], v[32:35]
  ds_read_b64_tr_b16 a[80:81], v241 offset:128
  v_mfma_f32_16x16x32_bf16 v[36:39], a[16:19], a[220:223], v[36:39]
  ds_read_b64_tr_b16 a[82:83], v241 offset:4736
  v_mfma_f32_16x16x32_bf16 v[40:43], a[20:23], a[216:219], v[40:43]
  ds_read_b64_tr_b16 a[84:85], v241 offset:160
  buffer_load_dwordx4 a[148:151], v236, s[40:43], s24 offen offset:2048 sc1
  v_mfma_f32_16x16x32_bf16 v[44:47], a[20:23], a[220:223], v[44:47]
  ds_read_b64_tr_b16 a[86:87], v241 offset:4768
  v_mfma_f32_16x16x32_bf16 v[48:51], a[24:27], a[216:219], v[48:51]
  ds_read_b64_tr_b16 a[88:89], v241 offset:192
  v_mfma_f32_16x16x32_bf16 v[52:55], a[24:27], a[220:223], v[52:55]
  ds_read_b64_tr_b16 a[90:91], v241 offset:4800
  v_mfma_f32_16x16x32_bf16 v[56:59], a[28:31], a[216:219], v[56:59]
  ds_read_b64_tr_b16 a[92:93], v241 offset:224
  buffer_load_dwordx4 a[152:155], v208, s[40:43], s24 offen offset:3072 sc1
  v_mfma_f32_16x16x32_bf16 v[60:63], a[28:31], a[220:223], v[60:63]
  ds_read_b64_tr_b16 a[94:95], v241 offset:4832
  ds_read_b64_tr_b16 a[96:97], v241 offset:256
  ds_read_b64_tr_b16 a[98:99], v241 offset:4864
  v_mfma_f32_16x16x32_bf16 v[64:67], a[32:35], a[216:219], v[64:67]
  v_mfma_f32_16x16x32_bf16 v[68:71], a[32:35], a[220:223], v[68:71]
  s_waitcnt vmcnt(22)
  s_waitcnt lgkmcnt(3)
  v_mfma_f32_16x16x32_bf16 v[0:3], a[64:67], a[224:227], v[0:3]
  ds_read_b64_tr_b16 a[0:1], v241 offset:9216
  v_mfma_f32_16x16x32_bf16 v[4:7], a[64:67], a[228:231], v[4:7]
  ds_read_b64_tr_b16 a[2:3], v241 offset:13824
  v_mfma_f32_16x16x32_bf16 v[8:11], a[68:71], a[224:227], v[8:11]
  ds_read_b64_tr_b16 a[4:5], v241 offset:9248
  buffer_load_dwordx4 a[156:159], v236, s[40:43], s24 offen offset:3072 sc1
  v_mfma_f32_16x16x32_bf16 v[12:15], a[68:71], a[228:231], v[12:15]
  ds_read_b64_tr_b16 a[6:7], v241 offset:13856
  v_mfma_f32_16x16x32_bf16 v[16:19], a[72:75], a[224:227], v[16:19]
  ds_read_b64_tr_b16 a[8:9], v241 offset:9280
  v_mfma_f32_16x16x32_bf16 v[20:23], a[72:75], a[228:231], v[20:23]
  ds_read_b64_tr_b16 a[10:11], v241 offset:13888
  s_add_u32 m0, s5, 126976
  v_mfma_f32_16x16x32_bf16 v[24:27], a[76:79], a[224:227], v[24:27]
  ds_read_b64_tr_b16 a[12:13], v241 offset:9312
  buffer_load_dwordx4 v198, s[36:39], s29 offen offset:0  lds
  v_mfma_f32_16x16x32_bf16 v[28:31], a[76:79], a[228:231], v[28:31]
  ds_read_b64_tr_b16 a[14:15], v241 offset:13920
  v_mfma_f32_16x16x32_bf16 v[32:35], a[80:83], a[224:227], v[32:35]
  ds_read_b64_tr_b16 a[16:17], v241 offset:9344
  v_mfma_f32_16x16x32_bf16 v[36:39], a[80:83], a[228:231], v[36:39]
  ds_read_b64_tr_b16 a[18:19], v241 offset:13952
  s_add_u32 m0, s5, 126976
  v_mfma_f32_16x16x32_bf16 v[40:43], a[84:87], a[224:227], v[40:43]
  ds_read_b64_tr_b16 a[20:21], v241 offset:9376
  buffer_load_dwordx4 v199, s[36:39], s29 offen offset:1024  lds
  v_mfma_f32_16x16x32_bf16 v[44:47], a[84:87], a[228:231], v[44:47]
  ds_read_b64_tr_b16 a[22:23], v241 offset:13984
  v_mfma_f32_16x16x32_bf16 v[48:51], a[88:91], a[224:227], v[48:51]
  ds_read_b64_tr_b16 a[24:25], v241 offset:9408
  v_mfma_f32_16x16x32_bf16 v[52:55], a[88:91], a[228:231], v[52:55]
  ds_read_b64_tr_b16 a[26:27], v241 offset:14016
  s_add_u32 m0, s5, 126976
  s_waitcnt lgkmcnt(3)
  v_mfma_f32_16x16x32_bf16 v[56:59], a[92:95], a[224:227], v[56:59]
  ds_read_b64_tr_b16 a[28:29], v241 offset:9440
  buffer_load_dwordx4 v200, s[36:39], s29 offen offset:2048  lds
  v_mfma_f32_16x16x32_bf16 v[60:63], a[92:95], a[228:231], v[60:63]
  ds_read_b64_tr_b16 a[30:31], v241 offset:14048
  ds_read_b64_tr_b16 a[32:33], v241 offset:9472
  ds_read_b64_tr_b16 a[34:35], v241 offset:14080
  v_mfma_f32_16x16x32_bf16 v[64:67], a[96:99], a[224:227], v[64:67]
  v_mfma_f32_16x16x32_bf16 v[68:71], a[96:99], a[228:231], v[68:71]
  s_waitcnt vmcnt(24)
  v_mfma_f32_16x16x32_bf16 v[0:3], a[0:3], a[232:235], v[0:3]
  ds_read_b64_tr_b16 a[64:65], v241 offset:18432
  v_mfma_f32_16x16x32_bf16 v[4:7], a[0:3], a[236:239], v[4:7]
  ds_read_b64_tr_b16 a[66:67], v241 offset:23040
  s_add_u32 m0, s5, 130048
  v_mfma_f32_16x16x32_bf16 v[8:11], a[4:7], a[232:235], v[8:11]
  ds_read_b64_tr_b16 a[68:69], v241 offset:18464
  buffer_load_dwordx4 v201, s[36:39], s29 offen offset:0  lds
  v_mfma_f32_16x16x32_bf16 v[12:15], a[4:7], a[236:239], v[12:15]
  ds_read_b64_tr_b16 a[70:71], v241 offset:23072
  v_mfma_f32_16x16x32_bf16 v[16:19], a[8:11], a[232:235], v[16:19]
  ds_read_b64_tr_b16 a[72:73], v241 offset:18496
  v_mfma_f32_16x16x32_bf16 v[20:23], a[8:11], a[236:239], v[20:23]
  ds_read_b64_tr_b16 a[74:75], v241 offset:23104
  s_add_u32 m0, s5, 130048
  v_mfma_f32_16x16x32_bf16 v[24:27], a[12:15], a[232:235], v[24:27]
  ds_read_b64_tr_b16 a[76:77], v241 offset:18528
  buffer_load_dwordx4 v202, s[36:39], s29 offen offset:1024  lds
  v_mfma_f32_16x16x32_bf16 v[28:31], a[12:15], a[236:239], v[28:31]
  ds_read_b64_tr_b16 a[78:79], v241 offset:23136
  v_mfma_f32_16x16x32_bf16 v[32:35], a[16:19], a[232:235], v[32:35]
  ds_read_b64_tr_b16 a[80:81], v241 offset:18560
  v_mfma_f32_16x16x32_bf16 v[36:39], a[16:19], a[236:239], v[36:39]
  ds_read_b64_tr_b16 a[82:83], v241 offset:23168
  s_add_u32 m0, s5, 130048
  s_waitcnt lgkmcnt(3)
  v_mfma_f32_16x16x32_bf16 v[40:43], a[20:23], a[232:235], v[40:43]
  ds_read_b64_tr_b16 a[84:85], v241 offset:18592
  buffer_load_dwordx4 v203, s[36:39], s29 offen offset:2048  lds
  v_mfma_f32_16x16x32_bf16 v[44:47], a[20:23], a[236:239], v[44:47]
  ds_read_b64_tr_b16 a[86:87], v241 offset:23200
  v_mfma_f32_16x16x32_bf16 v[48:51], a[24:27], a[232:235], v[48:51]
  ds_read_b64_tr_b16 a[88:89], v241 offset:18624
  v_mfma_f32_16x16x32_bf16 v[52:55], a[24:27], a[236:239], v[52:55]
  ds_read_b64_tr_b16 a[90:91], v241 offset:23232
  s_add_u32 m0, s5, 133120
  v_mfma_f32_16x16x32_bf16 v[56:59], a[28:31], a[232:235], v[56:59]
  ds_read_b64_tr_b16 a[92:93], v241 offset:18656
  buffer_load_dwordx4 v204, s[36:39], s29 offen offset:0  lds
  v_mfma_f32_16x16x32_bf16 v[60:63], a[28:31], a[236:239], v[60:63]
  ds_read_b64_tr_b16 a[94:95], v241 offset:23264
  ds_read_b64_tr_b16 a[96:97], v241 offset:18688
  ds_read_b64_tr_b16 a[98:99], v241 offset:23296
  v_mfma_f32_16x16x32_bf16 v[64:67], a[32:35], a[232:235], v[64:67]
  v_mfma_f32_16x16x32_bf16 v[68:71], a[32:35], a[236:239], v[68:71]
  s_waitcnt vmcnt(26)
  v_mfma_f32_16x16x32_bf16 v[0:3], a[64:67], a[240:243], v[0:3]
  ds_read_b64_tr_b16 a[0:1], v241 offset:27648
  v_mfma_f32_16x16x32_bf16 v[4:7], a[64:67], a[244:247], v[4:7]
  ds_read_b64_tr_b16 a[2:3], v241 offset:32256
  s_add_u32 m0, s5, 133120
  v_mfma_f32_16x16x32_bf16 v[8:11], a[68:71], a[240:243], v[8:11]
  ds_read_b64_tr_b16 a[4:5], v241 offset:27680
  buffer_load_dwordx4 v205, s[36:39], s29 offen offset:1024  lds
  v_mfma_f32_16x16x32_bf16 v[12:15], a[68:71], a[244:247], v[12:15]
  ds_read_b64_tr_b16 a[6:7], v241 offset:32288
  v_mfma_f32_16x16x32_bf16 v[16:19], a[72:75], a[240:243], v[16:19]
  ds_read_b64_tr_b16 a[8:9], v241 offset:27712
  v_mfma_f32_16x16x32_bf16 v[20:23], a[72:75], a[244:247], v[20:23]
  ds_read_b64_tr_b16 a[10:11], v241 offset:32320
  s_add_u32 m0, s5, 133120
  s_waitcnt lgkmcnt(3)
  v_mfma_f32_16x16x32_bf16 v[24:27], a[76:79], a[240:243], v[24:27]
  ds_read_b64_tr_b16 a[12:13], v241 offset:27744
  buffer_load_dwordx4 v206, s[36:39], s29 offen offset:2048  lds
  v_mfma_f32_16x16x32_bf16 v[28:31], a[76:79], a[244:247], v[28:31]
  ds_read_b64_tr_b16 a[14:15], v241 offset:32352
  v_mfma_f32_16x16x32_bf16 v[32:35], a[80:83], a[240:243], v[32:35]
  ds_read_b64_tr_b16 a[16:17], v241 offset:27776
  v_mfma_f32_16x16x32_bf16 v[36:39], a[80:83], a[244:247], v[36:39]
  ds_read_b64_tr_b16 a[18:19], v241 offset:32384
  v_mfma_f32_16x16x32_bf16 v[40:43], a[84:87], a[240:243], v[40:43]
  ds_read_b64_tr_b16 a[20:21], v241 offset:27808
  buffer_load_dwordx4 a[160:163], v208, s[40:43], s25 offen offset:0 sc1
  v_mfma_f32_16x16x32_bf16 v[44:47], a[84:87], a[244:247], v[44:47]
  ds_read_b64_tr_b16 a[22:23], v241 offset:32416
  v_mfma_f32_16x16x32_bf16 v[48:51], a[88:91], a[240:243], v[48:51]
  ds_read_b64_tr_b16 a[24:25], v241 offset:27840
  v_mfma_f32_16x16x32_bf16 v[52:55], a[88:91], a[244:247], v[52:55]
  ds_read_b64_tr_b16 a[26:27], v241 offset:32448
  v_mfma_f32_16x16x32_bf16 v[56:59], a[92:95], a[240:243], v[56:59]
  ds_read_b64_tr_b16 a[28:29], v241 offset:27872
  buffer_load_dwordx4 a[164:167], v236, s[40:43], s25 offen offset:0 sc1
  v_mfma_f32_16x16x32_bf16 v[60:63], a[92:95], a[244:247], v[60:63]
  ds_read_b64_tr_b16 a[30:31], v241 offset:32480
  ds_read_b64_tr_b16 a[32:33], v241 offset:27904
  ds_read_b64_tr_b16 a[34:35], v241 offset:32512
  v_mfma_f32_16x16x32_bf16 v[64:67], a[96:99], a[240:243], v[64:67]
  v_mfma_f32_16x16x32_bf16 v[68:71], a[96:99], a[244:247], v[68:71]
  s_waitcnt vmcnt(28)
  s_waitcnt vmcnt(19) lgkmcnt(0)
  s_barrier
  v_mfma_f32_16x16x32_bf16 v[0:3], a[0:3], a[248:251], v[0:3]
  ds_read_b64_tr_b16 a[64:65], v238 offset:0
  v_mfma_f32_16x16x32_bf16 v[4:7], a[0:3], a[252:255], v[4:7]
  ds_read_b64_tr_b16 a[66:67], v238 offset:4608
  v_mfma_f32_16x16x32_bf16 v[8:11], a[4:7], a[248:251], v[8:11]
  ds_read_b64_tr_b16 a[68:69], v238 offset:32
  buffer_load_dwordx4 a[168:171], v208, s[40:43], s25 offen offset:1024 sc1
  v_mfma_f32_16x16x32_bf16 v[12:15], a[4:7], a[252:255], v[12:15]
  ds_read_b64_tr_b16 a[70:71], v238 offset:4640
  v_mfma_f32_16x16x32_bf16 v[16:19], a[8:11], a[248:251], v[16:19]
  ds_read_b64_tr_b16 a[72:73], v238 offset:64
  v_mfma_f32_16x16x32_bf16 v[20:23], a[8:11], a[252:255], v[20:23]
  ds_read_b64_tr_b16 a[74:75], v238 offset:4672
  v_mfma_f32_16x16x32_bf16 v[24:27], a[12:15], a[248:251], v[24:27]
  ds_read_b64_tr_b16 a[76:77], v238 offset:96
  buffer_load_dwordx4 a[172:175], v236, s[40:43], s25 offen offset:1024 sc1
  v_mfma_f32_16x16x32_bf16 v[28:31], a[12:15], a[252:255], v[28:31]
  ds_read_b64_tr_b16 a[78:79], v238 offset:4704
  v_mfma_f32_16x16x32_bf16 v[32:35], a[16:19], a[248:251], v[32:35]
  ds_read_b64_tr_b16 a[80:81], v238 offset:128
  v_mfma_f32_16x16x32_bf16 v[36:39], a[16:19], a[252:255], v[36:39]
  ds_read_b64_tr_b16 a[82:83], v238 offset:4736
  v_mfma_f32_16x16x32_bf16 v[40:43], a[20:23], a[248:251], v[40:43]
  ds_read_b64_tr_b16 a[84:85], v238 offset:160
  buffer_load_dwordx4 a[176:179], v208, s[40:43], s25 offen offset:2048 sc1
  v_mfma_f32_16x16x32_bf16 v[44:47], a[20:23], a[252:255], v[44:47]
  ds_read_b64_tr_b16 a[86:87], v238 offset:4768
  v_mfma_f32_16x16x32_bf16 v[48:51], a[24:27], a[248:251], v[48:51]
  ds_read_b64_tr_b16 a[88:89], v238 offset:192
  v_mfma_f32_16x16x32_bf16 v[52:55], a[24:27], a[252:255], v[52:55]
  ds_read_b64_tr_b16 a[90:91], v238 offset:4800
  v_mfma_f32_16x16x32_bf16 v[56:59], a[28:31], a[248:251], v[56:59]
  ds_read_b64_tr_b16 a[92:93], v238 offset:224
  buffer_load_dwordx4 a[180:183], v236, s[40:43], s25 offen offset:2048 sc1
  v_mfma_f32_16x16x32_bf16 v[60:63], a[28:31], a[252:255], v[60:63]
  ds_read_b64_tr_b16 a[94:95], v238 offset:4832
  ds_read_b64_tr_b16 a[96:97], v238 offset:256
  ds_read_b64_tr_b16 a[98:99], v238 offset:4864
  v_mfma_f32_16x16x32_bf16 v[64:67], a[32:35], a[248:251], v[64:67]
  v_mfma_f32_16x16x32_bf16 v[68:71], a[32:35], a[252:255], v[68:71]
  s_waitcnt vmcnt(21)
  s_waitcnt lgkmcnt(3)
  v_mfma_f32_16x16x32_bf16 v[0:3], a[64:67], a[128:131], v[0:3]
  ds_read_b64_tr_b16 a[0:1], v238 offset:9216
  v_mfma_f32_16x16x32_bf16 v[4:7], a[64:67], a[132:135], v[4:7]
  ds_read_b64_tr_b16 a[2:3], v238 offset:13824
  v_mfma_f32_16x16x32_bf16 v[8:11], a[68:71], a[128:131], v[8:11]
  ds_read_b64_tr_b16 a[4:5], v238 offset:9248
  buffer_load_dwordx4 a[184:187], v208, s[40:43], s25 offen offset:3072 sc1
  v_mfma_f32_16x16x32_bf16 v[12:15], a[68:71], a[132:135], v[12:15]
  ds_read_b64_tr_b16 a[6:7], v238 offset:13856
  v_mfma_f32_16x16x32_bf16 v[16:19], a[72:75], a[128:131], v[16:19]
  ds_read_b64_tr_b16 a[8:9], v238 offset:9280
  v_mfma_f32_16x16x32_bf16 v[20:23], a[72:75], a[132:135], v[20:23]
  ds_read_b64_tr_b16 a[10:11], v238 offset:13888
  v_mfma_f32_16x16x32_bf16 v[24:27], a[76:79], a[128:131], v[24:27]
  ds_read_b64_tr_b16 a[12:13], v238 offset:9312
  buffer_load_dwordx4 a[188:191], v236, s[40:43], s25 offen offset:3072 sc1
  v_mfma_f32_16x16x32_bf16 v[28:31], a[76:79], a[132:135], v[28:31]
  ds_read_b64_tr_b16 a[14:15], v238 offset:13920
  v_mfma_f32_16x16x32_bf16 v[32:35], a[80:83], a[128:131], v[32:35]
  ds_read_b64_tr_b16 a[16:17], v238 offset:9344
  v_mfma_f32_16x16x32_bf16 v[36:39], a[80:83], a[132:135], v[36:39]
  ds_read_b64_tr_b16 a[18:19], v238 offset:13952
  s_add_u32 m0, s5, 36864
  v_mfma_f32_16x16x32_bf16 v[40:43], a[84:87], a[128:131], v[40:43]
  ds_read_b64_tr_b16 a[20:21], v238 offset:9376
  buffer_load_dwordx4 v198, s[36:39], s30 offen offset:0  lds
  v_mfma_f32_16x16x32_bf16 v[44:47], a[84:87], a[132:135], v[44:47]
  ds_read_b64_tr_b16 a[22:23], v238 offset:13984
  v_mfma_f32_16x16x32_bf16 v[48:51], a[88:91], a[128:131], v[48:51]
  ds_read_b64_tr_b16 a[24:25], v238 offset:9408
  v_mfma_f32_16x16x32_bf16 v[52:55], a[88:91], a[132:135], v[52:55]
  ds_read_b64_tr_b16 a[26:27], v238 offset:14016
  s_add_u32 m0, s5, 36864
  s_waitcnt lgkmcnt(3)
  v_mfma_f32_16x16x32_bf16 v[56:59], a[92:95], a[128:131], v[56:59]
  ds_read_b64_tr_b16 a[28:29], v238 offset:9440
  buffer_load_dwordx4 v199, s[36:39], s30 offen offset:1024  lds
  v_mfma_f32_16x16x32_bf16 v[60:63], a[92:95], a[132:135], v[60:63]
  ds_read_b64_tr_b16 a[30:31], v238 offset:14048
  ds_read_b64_tr_b16 a[32:33], v238 offset:9472
  ds_read_b64_tr_b16 a[34:35], v238 offset:14080
  v_mfma_f32_16x16x32_bf16 v[64:67], a[96:99], a[128:131], v[64:67]
  v_mfma_f32_16x16x32_bf16 v[68:71], a[96:99], a[132:135], v[68:71]
  s_waitcnt vmcnt(23)
  v_mfma_f32_16x16x32_bf16 v[0:3], a[0:3], a[136:139], v[0:3]
  ds_read_b64_tr_b16 a[64:65], v238 offset:18432
  v_mfma_f32_16x16x32_bf16 v[4:7], a[0:3], a[140:143], v[4:7]
  ds_read_b64_tr_b16 a[66:67], v238 offset:23040
  s_add_u32 m0, s5, 36864
  v_mfma_f32_16x16x32_bf16 v[8:11], a[4:7], a[136:139], v[8:11]
  ds_read_b64_tr_b16 a[68:69], v238 offset:18464
  buffer_load_dwordx4 v200, s[36:39], s30 offen offset:2048  lds
  v_mfma_f32_16x16x32_bf16 v[12:15], a[4:7], a[140:143], v[12:15]
  ds_read_b64_tr_b16 a[70:71], v238 offset:23072
  v_mfma_f32_16x16x32_bf16 v[16:19], a[8:11], a[136:139], v[16:19]
  ds_read_b64_tr_b16 a[72:73], v238 offset:18496
  v_mfma_f32_16x16x32_bf16 v[20:23], a[8:11], a[140:143], v[20:23]
  ds_read_b64_tr_b16 a[74:75], v238 offset:23104
  s_add_u32 m0, s5, 39936
  v_mfma_f32_16x16x32_bf16 v[24:27], a[12:15], a[136:139], v[24:27]
  ds_read_b64_tr_b16 a[76:77], v238 offset:18528
  buffer_load_dwordx4 v201, s[36:39], s30 offen offset:0  lds
  v_mfma_f32_16x16x32_bf16 v[28:31], a[12:15], a[140:143], v[28:31]
  ds_read_b64_tr_b16 a[78:79], v238 offset:23136
  v_mfma_f32_16x16x32_bf16 v[32:35], a[16:19], a[136:139], v[32:35]
  ds_read_b64_tr_b16 a[80:81], v238 offset:18560
  v_mfma_f32_16x16x32_bf16 v[36:39], a[16:19], a[140:143], v[36:39]
  ds_read_b64_tr_b16 a[82:83], v238 offset:23168
  s_add_u32 m0, s5, 39936
  s_waitcnt lgkmcnt(3)
  v_mfma_f32_16x16x32_bf16 v[40:43], a[20:23], a[136:139], v[40:43]
  ds_read_b64_tr_b16 a[84:85], v238 offset:18592
  buffer_load_dwordx4 v202, s[36:39], s30 offen offset:1024  lds
  v_mfma_f32_16x16x32_bf16 v[44:47], a[20:23], a[140:143], v[44:47]
  ds_read_b64_tr_b16 a[86:87], v238 offset:23200
  v_mfma_f32_16x16x32_bf16 v[48:51], a[24:27], a[136:139], v[48:51]
  ds_read_b64_tr_b16 a[88:89], v238 offset:18624
  v_mfma_f32_16x16x32_bf16 v[52:55], a[24:27], a[140:143], v[52:55]
  ds_read_b64_tr_b16 a[90:91], v238 offset:23232
  s_add_u32 m0, s5, 39936
  v_mfma_f32_16x16x32_bf16 v[56:59], a[28:31], a[136:139], v[56:59]
  ds_read_b64_tr_b16 a[92:93], v238 offset:18656
  buffer_load_dwordx4 v203, s[36:39], s30 offen offset:2048  lds
  v_mfma_f32_16x16x32_bf16 v[60:63], a[28:31], a[140:143], v[60:63]
  ds_read_b64_tr_b16 a[94:95], v238 offset:23264
  ds_read_b64_tr_b16 a[96:97], v238 offset:18688
  ds_read_b64_tr_b16 a[98:99], v238 offset:23296
  v_mfma_f32_16x16x32_bf16 v[64:67], a[32:35], a[136:139], v[64:67]
  v_mfma_f32_16x16x32_bf16 v[68:71], a[32:35], a[140:143], v[68:71]
  s_waitcnt vmcnt(25)
  v_mfma_f32_16x16x32_bf16 v[0:3], a[64:67], a[144:147], v[0:3]
  ds_read_b64_tr_b16 a[0:1], v238 offset:27648
  v_mfma_f32_16x16x32_bf16 v[4:7], a[64:67], a[148:151], v[4:7]
  ds_read_b64_tr_b16 a[2:3], v238 offset:32256
  s_add_u32 m0, s5, 43008
  v_mfma_f32_16x16x32_bf16 v[8:11], a[68:71], a[144:147], v[8:11]
  ds_read_b64_tr_b16 a[4:5], v238 offset:27680
  buffer_load_dwordx4 v204, s[36:39], s30 offen offset:0  lds
  v_mfma_f32_16x16x32_bf16 v[12:15], a[68:71], a[148:151], v[12:15]
  ds_read_b64_tr_b16 a[6:7], v238 offset:32288
  v_mfma_f32_16x16x32_bf16 v[16:19], a[72:75], a[144:147], v[16:19]
  ds_read_b64_tr_b16 a[8:9], v238 offset:27712
  v_mfma_f32_16x16x32_bf16 v[20:23], a[72:75], a[148:151], v[20:23]
  ds_read_b64_tr_b16 a[10:11], v238 offset:32320
  s_add_u32 m0, s5, 43008
  s_waitcnt lgkmcnt(3)
  v_mfma_f32_16x16x32_bf16 v[24:27], a[76:79], a[144:147], v[24:27]
  ds_read_b64_tr_b16 a[12:13], v238 offset:27744
  buffer_load_dwordx4 v205, s[36:39], s30 offen offset:1024  lds
  v_mfma_f32_16x16x32_bf16 v[28:31], a[76:79], a[148:151], v[28:31]
  ds_read_b64_tr_b16 a[14:15], v238 offset:32352
  v_mfma_f32_16x16x32_bf16 v[32:35], a[80:83], a[144:147], v[32:35]
  ds_read_b64_tr_b16 a[16:17], v238 offset:27776
  v_mfma_f32_16x16x32_bf16 v[36:39], a[80:83], a[148:151], v[36:39]
  ds_read_b64_tr_b16 a[18:19], v238 offset:32384
  s_add_u32 m0, s5, 43008
  v_mfma_f32_16x16x32_bf16 v[40:43], a[84:87], a[144:147], v[40:43]
  ds_read_b64_tr_b16 a[20:21], v238 offset:27808
  buffer_load_dwordx4 v206, s[36:39], s30 offen offset:2048  lds
  v_mfma_f32_16x16x32_bf16 v[44:47], a[84:87], a[148:151], v[44:47]
  ds_read_b64_tr_b16 a[22:23], v238 offset:32416
  v_mfma_f32_16x16x32_bf16 v[48:51], a[88:91], a[144:147], v[48:51]
  ds_read_b64_tr_b16 a[24:25], v238 offset:27840
  v_mfma_f32_16x16x32_bf16 v[52:55], a[88:91], a[148:151], v[52:55]
  ds_read_b64_tr_b16 a[26:27], v238 offset:32448
  v_mfma_f32_16x16x32_bf16 v[56:59], a[92:95], a[144:147], v[56:59]
  ds_read_b64_tr_b16 a[28:29], v238 offset:27872
  buffer_load_dwordx4 a[192:195], v208, s[40:43], s26 offen offset:0 sc1
  v_mfma_f32_16x16x32_bf16 v[60:63], a[92:95], a[148:151], v[60:63]
  ds_read_b64_tr_b16 a[30:31], v238 offset:32480
  ds_read_b64_tr_b16 a[32:33], v238 offset:27904
  ds_read_b64_tr_b16 a[34:35], v238 offset:32512
  v_mfma_f32_16x16x32_bf16 v[64:67], a[96:99], a[144:147], v[64:67]
  v_mfma_f32_16x16x32_bf16 v[68:71], a[96:99], a[148:151], v[68:71]
  s_waitcnt vmcnt(27)
  s_waitcnt vmcnt(18) lgkmcnt(0)
  s_barrier
  v_mfma_f32_16x16x32_bf16 v[0:3], a[0:3], a[152:155], v[0:3]
  ds_read_b64_tr_b16 a[64:65], v239 offset:0
  v_mfma_f32_16x16x32_bf16 v[4:7], a[0:3], a[156:159], v[4:7]
  ds_read_b64_tr_b16 a[66:67], v239 offset:4608
  v_mfma_f32_16x16x32_bf16 v[8:11], a[4:7], a[152:155], v[8:11]
  ds_read_b64_tr_b16 a[68:69], v239 offset:32
  buffer_load_dwordx4 a[196:199], v236, s[40:43], s26 offen offset:0 sc1
  v_mfma_f32_16x16x32_bf16 v[12:15], a[4:7], a[156:159], v[12:15]
  ds_read_b64_tr_b16 a[70:71], v239 offset:4640
  v_mfma_f32_16x16x32_bf16 v[16:19], a[8:11], a[152:155], v[16:19]
  ds_read_b64_tr_b16 a[72:73], v239 offset:64
  v_mfma_f32_16x16x32_bf16 v[20:23], a[8:11], a[156:159], v[20:23]
  ds_read_b64_tr_b16 a[74:75], v239 offset:4672
  v_mfma_f32_16x16x32_bf16 v[24:27], a[12:15], a[152:155], v[24:27]
  ds_read_b64_tr_b16 a[76:77], v239 offset:96
  buffer_load_dwordx4 a[200:203], v208, s[40:43], s26 offen offset:1024 sc1
  v_mfma_f32_16x16x32_bf16 v[28:31], a[12:15], a[156:159], v[28:31]
  ds_read_b64_tr_b16 a[78:79], v239 offset:4704
  v_mfma_f32_16x16x32_bf16 v[32:35], a[16:19], a[152:155], v[32:35]
  ds_read_b64_tr_b16 a[80:81], v239 offset:128
  v_mfma_f32_16x16x32_bf16 v[36:39], a[16:19], a[156:159], v[36:39]
  ds_read_b64_tr_b16 a[82:83], v239 offset:4736
  v_mfma_f32_16x16x32_bf16 v[40:43], a[20:23], a[152:155], v[40:43]
  ds_read_b64_tr_b16 a[84:85], v239 offset:160
  buffer_load_dwordx4 a[204:207], v236, s[40:43], s26 offen offset:1024 sc1
  v_mfma_f32_16x16x32_bf16 v[44:47], a[20:23], a[156:159], v[44:47]
  ds_read_b64_tr_b16 a[86:87], v239 offset:4768
  v_mfma_f32_16x16x32_bf16 v[48:51], a[24:27], a[152:155], v[48:51]
  ds_read_b64_tr_b16 a[88:89], v239 offset:192
  v_mfma_f32_16x16x32_bf16 v[52:55], a[24:27], a[156:159], v[52:55]
  ds_read_b64_tr_b16 a[90:91], v239 offset:4800
  v_mfma_f32_16x16x32_bf16 v[56:59], a[28:31], a[152:155], v[56:59]
  ds_read_b64_tr_b16 a[92:93], v239 offset:224
  buffer_load_dwordx4 a[208:211], v208, s[40:43], s26 offen offset:2048 sc1
  v_mfma_f32_16x16x32_bf16 v[60:63], a[28:31], a[156:159], v[60:63]
  ds_read_b64_tr_b16 a[94:95], v239 offset:4832
  ds_read_b64_tr_b16 a[96:97], v239 offset:256
  ds_read_b64_tr_b16 a[98:99], v239 offset:4864
  v_mfma_f32_16x16x32_bf16 v[64:67], a[32:35], a[152:155], v[64:67]
  v_mfma_f32_16x16x32_bf16 v[68:71], a[32:35], a[156:159], v[68:71]
  s_waitcnt vmcnt(20)
  s_waitcnt lgkmcnt(3)
  v_mfma_f32_16x16x32_bf16 v[0:3], a[64:67], a[160:163], v[0:3]
  ds_read_b64_tr_b16 a[0:1], v239 offset:9216
  v_mfma_f32_16x16x32_bf16 v[4:7], a[64:67], a[164:167], v[4:7]
  ds_read_b64_tr_b16 a[2:3], v239 offset:13824
  v_mfma_f32_16x16x32_bf16 v[8:11], a[68:71], a[160:163], v[8:11]
  ds_read_b64_tr_b16 a[4:5], v239 offset:9248
  buffer_load_dwordx4 a[212:215], v236, s[40:43], s26 offen offset:2048 sc1
  v_mfma_f32_16x16x32_bf16 v[12:15], a[68:71], a[164:167], v[12:15]
  ds_read_b64_tr_b16 a[6:7], v239 offset:13856
  v_mfma_f32_16x16x32_bf16 v[16:19], a[72:75], a[160:163], v[16:19]
  ds_read_b64_tr_b16 a[8:9], v239 offset:9280
  v_mfma_f32_16x16x32_bf16 v[20:23], a[72:75], a[164:167], v[20:23]
  ds_read_b64_tr_b16 a[10:11], v239 offset:13888
  v_mfma_f32_16x16x32_bf16 v[24:27], a[76:79], a[160:163], v[24:27]
  ds_read_b64_tr_b16 a[12:13], v239 offset:9312
  buffer_load_dwordx4 a[216:219], v208, s[40:43], s26 offen offset:3072 sc1
  v_mfma_f32_16x16x32_bf16 v[28:31], a[76:79], a[164:167], v[28:31]
  ds_read_b64_tr_b16 a[14:15], v239 offset:13920
  v_mfma_f32_16x16x32_bf16 v[32:35], a[80:83], a[160:163], v[32:35]
  ds_read_b64_tr_b16 a[16:17], v239 offset:9344
  v_mfma_f32_16x16x32_bf16 v[36:39], a[80:83], a[164:167], v[36:39]
  ds_read_b64_tr_b16 a[18:19], v239 offset:13952
  v_mfma_f32_16x16x32_bf16 v[40:43], a[84:87], a[160:163], v[40:43]
  ds_read_b64_tr_b16 a[20:21], v239 offset:9376
  buffer_load_dwordx4 a[220:223], v236, s[40:43], s26 offen offset:3072 sc1
  v_mfma_f32_16x16x32_bf16 v[44:47], a[84:87], a[164:167], v[44:47]
  ds_read_b64_tr_b16 a[22:23], v239 offset:13984
  v_mfma_f32_16x16x32_bf16 v[48:51], a[88:91], a[160:163], v[48:51]
  ds_read_b64_tr_b16 a[24:25], v239 offset:9408
  v_mfma_f32_16x16x32_bf16 v[52:55], a[88:91], a[164:167], v[52:55]
  ds_read_b64_tr_b16 a[26:27], v239 offset:14016
  s_add_u32 m0, s5, 0
  s_waitcnt lgkmcnt(3)
  v_mfma_f32_16x16x32_bf16 v[56:59], a[92:95], a[160:163], v[56:59]
  ds_read_b64_tr_b16 a[28:29], v239 offset:9440
  buffer_load_dwordx4 v198, s[36:39], s31 offen offset:0  lds
  v_mfma_f32_16x16x32_bf16 v[60:63], a[92:95], a[164:167], v[60:63]
  ds_read_b64_tr_b16 a[30:31], v239 offset:14048
  ds_read_b64_tr_b16 a[32:33], v239 offset:9472
  ds_read_b64_tr_b16 a[34:35], v239 offset:14080
  v_mfma_f32_16x16x32_bf16 v[64:67], a[96:99], a[160:163], v[64:67]
  v_mfma_f32_16x16x32_bf16 v[68:71], a[96:99], a[164:167], v[68:71]
  s_waitcnt vmcnt(22)
  v_mfma_f32_16x16x32_bf16 v[0:3], a[0:3], a[168:171], v[0:3]
  ds_read_b64_tr_b16 a[64:65], v239 offset:18432
  v_mfma_f32_16x16x32_bf16 v[4:7], a[0:3], a[172:175], v[4:7]
  ds_read_b64_tr_b16 a[66:67], v239 offset:23040
  s_add_u32 m0, s5, 0
  v_mfma_f32_16x16x32_bf16 v[8:11], a[4:7], a[168:171], v[8:11]
  ds_read_b64_tr_b16 a[68:69], v239 offset:18464
  buffer_load_dwordx4 v199, s[36:39], s31 offen offset:1024  lds
  v_mfma_f32_16x16x32_bf16 v[12:15], a[4:7], a[172:175], v[12:15]
  ds_read_b64_tr_b16 a[70:71], v239 offset:23072
  v_mfma_f32_16x16x32_bf16 v[16:19], a[8:11], a[168:171], v[16:19]
  ds_read_b64_tr_b16 a[72:73], v239 offset:18496
  v_mfma_f32_16x16x32_bf16 v[20:23], a[8:11], a[172:175], v[20:23]
  ds_read_b64_tr_b16 a[74:75], v239 offset:23104
  s_add_u32 m0, s5, 0
  v_mfma_f32_16x16x32_bf16 v[24:27], a[12:15], a[168:171], v[24:27]
  ds_read_b64_tr_b16 a[76:77], v239 offset:18528
  buffer_load_dwordx4 v200, s[36:39], s31 offen offset:2048  lds
  v_mfma_f32_16x16x32_bf16 v[28:31], a[12:15], a[172:175], v[28:31]
  ds_read_b64_tr_b16 a[78:79], v239 offset:23136
  v_mfma_f32_16x16x32_bf16 v[32:35], a[16:19], a[168:171], v[32:35]
  ds_read_b64_tr_b16 a[80:81], v239 offset:18560
  v_mfma_f32_16x16x32_bf16 v[36:39], a[16:19], a[172:175], v[36:39]
  ds_read_b64_tr_b16 a[82:83], v239 offset:23168
  s_add_u32 m0, s5, 3072
  s_waitcnt lgkmcnt(3)
  v_mfma_f32_16x16x32_bf16 v[40:43], a[20:23], a[168:171], v[40:43]
  ds_read_b64_tr_b16 a[84:85], v239 offset:18592
  buffer_load_dwordx4 v201, s[36:39], s31 offen offset:0  lds
  v_mfma_f32_16x16x32_bf16 v[44:47], a[20:23], a[172:175], v[44:47]
  ds_read_b64_tr_b16 a[86:87], v239 offset:23200
  v_mfma_f32_16x16x32_bf16 v[48:51], a[24:27], a[168:171], v[48:51]
  ds_read_b64_tr_b16 a[88:89], v239 offset:18624
  v_mfma_f32_16x16x32_bf16 v[52:55], a[24:27], a[172:175], v[52:55]
  ds_read_b64_tr_b16 a[90:91], v239 offset:23232
  s_add_u32 m0, s5, 3072
  v_mfma_f32_16x16x32_bf16 v[56:59], a[28:31], a[168:171], v[56:59]
  ds_read_b64_tr_b16 a[92:93], v239 offset:18656
  buffer_load_dwordx4 v202, s[36:39], s31 offen offset:1024  lds
  v_mfma_f32_16x16x32_bf16 v[60:63], a[28:31], a[172:175], v[60:63]
  ds_read_b64_tr_b16 a[94:95], v239 offset:23264
  ds_read_b64_tr_b16 a[96:97], v239 offset:18688
  ds_read_b64_tr_b16 a[98:99], v239 offset:23296
  v_mfma_f32_16x16x32_bf16 v[64:67], a[32:35], a[168:171], v[64:67]
  v_mfma_f32_16x16x32_bf16 v[68:71], a[32:35], a[172:175], v[68:71]
  s_waitcnt vmcnt(24)
  v_mfma_f32_16x16x32_bf16 v[0:3], a[64:67], a[176:179], v[0:3]
  ds_read_b64_tr_b16 a[0:1], v239 offset:27648
  v_mfma_f32_16x16x32_bf16 v[4:7], a[64:67], a[180:183], v[4:7]
  ds_read_b64_tr_b16 a[2:3], v239 offset:32256
  s_add_u32 m0, s5, 3072
  v_mfma_f32_16x16x32_bf16 v[8:11], a[68:71], a[176:179], v[8:11]
  ds_read_b64_tr_b16 a[4:5], v239 offset:27680
  buffer_load_dwordx4 v203, s[36:39], s31 offen offset:2048  lds
  v_mfma_f32_16x16x32_bf16 v[12:15], a[68:71], a[180:183], v[12:15]
  ds_read_b64_tr_b16 a[6:7], v239 offset:32288
  v_mfma_f32_16x16x32_bf16 v[16:19], a[72:75], a[176:179], v[16:19]
  ds_read_b64_tr_b16 a[8:9], v239 offset:27712
  v_mfma_f32_16x16x32_bf16 v[20:23], a[72:75], a[180:183], v[20:23]
  ds_read_b64_tr_b16 a[10:11], v239 offset:32320
  s_add_u32 m0, s5, 6144
  s_waitcnt lgkmcnt(3)
  v_mfma_f32_16x16x32_bf16 v[24:27], a[76:79], a[176:179], v[24:27]
  ds_read_b64_tr_b16 a[12:13], v239 offset:27744
  buffer_load_dwordx4 v204, s[36:39], s31 offen offset:0  lds
  v_mfma_f32_16x16x32_bf16 v[28:31], a[76:79], a[180:183], v[28:31]
  ds_read_b64_tr_b16 a[14:15], v239 offset:32352
  v_mfma_f32_16x16x32_bf16 v[32:35], a[80:83], a[176:179], v[32:35]
  ds_read_b64_tr_b16 a[16:17], v239 offset:27776
  v_mfma_f32_16x16x32_bf16 v[36:39], a[80:83], a[180:183], v[36:39]
  ds_read_b64_tr_b16 a[18:19], v239 offset:32384
  s_add_u32 m0, s5, 6144
  v_mfma_f32_16x16x32_bf16 v[40:43], a[84:87], a[176:179], v[40:43]
  ds_read_b64_tr_b16 a[20:21], v239 offset:27808
  buffer_load_dwordx4 v205, s[36:39], s31 offen offset:1024  lds
  v_mfma_f32_16x16x32_bf16 v[44:47], a[84:87], a[180:183], v[44:47]
  ds_read_b64_tr_b16 a[22:23], v239 offset:32416
  v_mfma_f32_16x16x32_bf16 v[48:51], a[88:91], a[176:179], v[48:51]
  ds_read_b64_tr_b16 a[24:25], v239 offset:27840
  v_mfma_f32_16x16x32_bf16 v[52:55], a[88:91], a[180:183], v[52:55]
  ds_read_b64_tr_b16 a[26:27], v239 offset:32448
  s_add_u32 m0, s5, 6144
  v_mfma_f32_16x16x32_bf16 v[56:59], a[92:95], a[176:179], v[56:59]
  ds_read_b64_tr_b16 a[28:29], v239 offset:27872
  buffer_load_dwordx4 v206, s[36:39], s31 offen offset:2048  lds
  v_mfma_f32_16x16x32_bf16 v[60:63], a[92:95], a[180:183], v[60:63]
  ds_read_b64_tr_b16 a[30:31], v239 offset:32480
  ds_read_b64_tr_b16 a[32:33], v239 offset:27904
  ds_read_b64_tr_b16 a[34:35], v239 offset:32512
  v_mfma_f32_16x16x32_bf16 v[64:67], a[96:99], a[176:179], v[64:67]
  v_mfma_f32_16x16x32_bf16 v[68:71], a[96:99], a[180:183], v[68:71]
  s_waitcnt vmcnt(26)
  s_waitcnt vmcnt(17) lgkmcnt(0)
  s_barrier
  v_mfma_f32_16x16x32_bf16 v[0:3], a[0:3], a[184:187], v[0:3]
  ds_read_b64_tr_b16 a[64:65], v240 offset:0
  v_mfma_f32_16x16x32_bf16 v[4:7], a[0:3], a[188:191], v[4:7]
  ds_read_b64_tr_b16 a[66:67], v240 offset:4608
  v_mfma_f32_16x16x32_bf16 v[8:11], a[4:7], a[184:187], v[8:11]
  ds_read_b64_tr_b16 a[68:69], v240 offset:32
  buffer_load_dwordx4 a[224:227], v208, s[40:43], s27 offen offset:0 sc1
  v_mfma_f32_16x16x32_bf16 v[12:15], a[4:7], a[188:191], v[12:15]
  ds_read_b64_tr_b16 a[70:71], v240 offset:4640
  v_mfma_f32_16x16x32_bf16 v[16:19], a[8:11], a[184:187], v[16:19]
  ds_read_b64_tr_b16 a[72:73], v240 offset:64
  v_mfma_f32_16x16x32_bf16 v[20:23], a[8:11], a[188:191], v[20:23]
  ds_read_b64_tr_b16 a[74:75], v240 offset:4672
  v_mfma_f32_16x16x32_bf16 v[24:27], a[12:15], a[184:187], v[24:27]
  ds_read_b64_tr_b16 a[76:77], v240 offset:96
  buffer_load_dwordx4 a[228:231], v236, s[40:43], s27 offen offset:0 sc1
  v_mfma_f32_16x16x32_bf16 v[28:31], a[12:15], a[188:191], v[28:31]
  ds_read_b64_tr_b16 a[78:79], v240 offset:4704
  v_mfma_f32_16x16x32_bf16 v[32:35], a[16:19], a[184:187], v[32:35]
  ds_read_b64_tr_b16 a[80:81], v240 offset:128
  v_mfma_f32_16x16x32_bf16 v[36:39], a[16:19], a[188:191], v[36:39]
  ds_read_b64_tr_b16 a[82:83], v240 offset:4736
  v_mfma_f32_16x16x32_bf16 v[40:43], a[20:23], a[184:187], v[40:43]
  ds_read_b64_tr_b16 a[84:85], v240 offset:160
  buffer_load_dwordx4 a[232:235], v208, s[40:43], s27 offen offset:1024 sc1
  v_mfma_f32_16x16x32_bf16 v[44:47], a[20:23], a[188:191], v[44:47]
  ds_read_b64_tr_b16 a[86:87], v240 offset:4768
  v_mfma_f32_16x16x32_bf16 v[48:51], a[24:27], a[184:187], v[48:51]
  ds_read_b64_tr_b16 a[88:89], v240 offset:192
  v_mfma_f32_16x16x32_bf16 v[52:55], a[24:27], a[188:191], v[52:55]
  ds_read_b64_tr_b16 a[90:91], v240 offset:4800
  v_mfma_f32_16x16x32_bf16 v[56:59], a[28:31], a[184:187], v[56:59]
  ds_read_b64_tr_b16 a[92:93], v240 offset:224
  buffer_load_dwordx4 a[236:239], v236, s[40:43], s27 offen offset:1024 sc1
  v_mfma_f32_16x16x32_bf16 v[60:63], a[28:31], a[188:191], v[60:63]
  ds_read_b64_tr_b16 a[94:95], v240 offset:4832
  ds_read_b64_tr_b16 a[96:97], v240 offset:256
  ds_read_b64_tr_b16 a[98:99], v240 offset:4864
  v_mfma_f32_16x16x32_bf16 v[64:67], a[32:35], a[184:187], v[64:67]
  v_mfma_f32_16x16x32_bf16 v[68:71], a[32:35], a[188:191], v[68:71]
  s_waitcnt vmcnt(19)
  s_waitcnt lgkmcnt(3)
  v_mfma_f32_16x16x32_bf16 v[0:3], a[64:67], a[192:195], v[0:3]
  ds_read_b64_tr_b16 a[0:1], v240 offset:9216
  v_mfma_f32_16x16x32_bf16 v[4:7], a[64:67], a[196:199], v[4:7]
  ds_read_b64_tr_b16 a[2:3], v240 offset:13824
  v_mfma_f32_16x16x32_bf16 v[8:11], a[68:71], a[192:195], v[8:11]
  ds_read_b64_tr_b16 a[4:5], v240 offset:9248
  buffer_load_dwordx4 a[240:243], v208, s[40:43], s27 offen offset:2048 sc1
  v_mfma_f32_16x16x32_bf16 v[12:15], a[68:71], a[196:199], v[12:15]
  ds_read_b64_tr_b16 a[6:7], v240 offset:13856
  v_mfma_f32_16x16x32_bf16 v[16:19], a[72:75], a[192:195], v[16:19]
  ds_read_b64_tr_b16 a[8:9], v240 offset:9280
  v_mfma_f32_16x16x32_bf16 v[20:23], a[72:75], a[196:199], v[20:23]
  ds_read_b64_tr_b16 a[10:11], v240 offset:13888
  v_mfma_f32_16x16x32_bf16 v[24:27], a[76:79], a[192:195], v[24:27]
  ds_read_b64_tr_b16 a[12:13], v240 offset:9312
  buffer_load_dwordx4 a[244:247], v236, s[40:43], s27 offen offset:2048 sc1
  v_mfma_f32_16x16x32_bf16 v[28:31], a[76:79], a[196:199], v[28:31]
  ds_read_b64_tr_b16 a[14:15], v240 offset:13920
  v_mfma_f32_16x16x32_bf16 v[32:35], a[80:83], a[192:195], v[32:35]
  ds_read_b64_tr_b16 a[16:17], v240 offset:9344
  v_mfma_f32_16x16x32_bf16 v[36:39], a[80:83], a[196:199], v[36:39]
  ds_read_b64_tr_b16 a[18:19], v240 offset:13952
  v_mfma_f32_16x16x32_bf16 v[40:43], a[84:87], a[192:195], v[40:43]
  ds_read_b64_tr_b16 a[20:21], v240 offset:9376
  buffer_load_dwordx4 a[248:251], v208, s[40:43], s27 offen offset:3072 sc1
  v_mfma_f32_16x16x32_bf16 v[44:47], a[84:87], a[196:199], v[44:47]
  ds_read_b64_tr_b16 a[22:23], v240 offset:13984
  v_mfma_f32_16x16x32_bf16 v[48:51], a[88:91], a[192:195], v[48:51]
  ds_read_b64_tr_b16 a[24:25], v240 offset:9408
  v_mfma_f32_16x16x32_bf16 v[52:55], a[88:91], a[196:199], v[52:55]
  ds_read_b64_tr_b16 a[26:27], v240 offset:14016
  s_waitcnt lgkmcnt(3)
  v_mfma_f32_16x16x32_bf16 v[56:59], a[92:95], a[192:195], v[56:59]
  ds_read_b64_tr_b16 a[28:29], v240 offset:9440
  buffer_load_dwordx4 a[252:255], v236, s[40:43], s27 offen offset:3072 sc1
  v_mfma_f32_16x16x32_bf16 v[60:63], a[92:95], a[196:199], v[60:63]
  ds_read_b64_tr_b16 a[30:31], v240 offset:14048
  ds_read_b64_tr_b16 a[32:33], v240 offset:9472
  ds_read_b64_tr_b16 a[34:35], v240 offset:14080
  v_mfma_f32_16x16x32_bf16 v[64:67], a[96:99], a[192:195], v[64:67]
  v_mfma_f32_16x16x32_bf16 v[68:71], a[96:99], a[196:199], v[68:71]
  s_waitcnt vmcnt(21)
  v_mfma_f32_16x16x32_bf16 v[0:3], a[0:3], a[200:203], v[0:3]
  ds_read_b64_tr_b16 a[64:65], v240 offset:18432
  v_mfma_f32_16x16x32_bf16 v[4:7], a[0:3], a[204:207], v[4:7]
  ds_read_b64_tr_b16 a[66:67], v240 offset:23040
  v_mfma_f32_16x16x32_bf16 v[8:11], a[4:7], a[200:203], v[8:11]
  ds_read_b64_tr_b16 a[68:69], v240 offset:18464
  v_mfma_f32_16x16x32_bf16 v[12:15], a[4:7], a[204:207], v[12:15]
  ds_read_b64_tr_b16 a[70:71], v240 offset:23072
  v_mfma_f32_16x16x32_bf16 v[16:19], a[8:11], a[200:203], v[16:19]
  ds_read_b64_tr_b16 a[72:73], v240 offset:18496
  v_mfma_f32_16x16x32_bf16 v[20:23], a[8:11], a[204:207], v[20:23]
  ds_read_b64_tr_b16 a[74:75], v240 offset:23104
  v_mfma_f32_16x16x32_bf16 v[24:27], a[12:15], a[200:203], v[24:27]
  ds_read_b64_tr_b16 a[76:77], v240 offset:18528
  v_mfma_f32_16x16x32_bf16 v[28:31], a[12:15], a[204:207], v[28:31]
  ds_read_b64_tr_b16 a[78:79], v240 offset:23136
  v_mfma_f32_16x16x32_bf16 v[32:35], a[16:19], a[200:203], v[32:35]
  ds_read_b64_tr_b16 a[80:81], v240 offset:18560
  v_mfma_f32_16x16x32_bf16 v[36:39], a[16:19], a[204:207], v[36:39]
  ds_read_b64_tr_b16 a[82:83], v240 offset:23168
  s_waitcnt lgkmcnt(3)
  v_mfma_f32_16x16x32_bf16 v[40:43], a[20:23], a[200:203], v[40:43]
  ds_read_b64_tr_b16 a[84:85], v240 offset:18592
  v_mfma_f32_16x16x32_bf16 v[44:47], a[20:23], a[204:207], v[44:47]
  ds_read_b64_tr_b16 a[86:87], v240 offset:23200
  v_mfma_f32_16x16x32_bf16 v[48:51], a[24:27], a[200:203], v[48:51]
  ds_read_b64_tr_b16 a[88:89], v240 offset:18624
  v_mfma_f32_16x16x32_bf16 v[52:55], a[24:27], a[204:207], v[52:55]
  ds_read_b64_tr_b16 a[90:91], v240 offset:23232
  v_mfma_f32_16x16x32_bf16 v[56:59], a[28:31], a[200:203], v[56:59]
  ds_read_b64_tr_b16 a[92:93], v240 offset:18656
  v_mfma_f32_16x16x32_bf16 v[60:63], a[28:31], a[204:207], v[60:63]
  ds_read_b64_tr_b16 a[94:95], v240 offset:23264
  ds_read_b64_tr_b16 a[96:97], v240 offset:18688
  ds_read_b64_tr_b16 a[98:99], v240 offset:23296
  v_mfma_f32_16x16x32_bf16 v[64:67], a[32:35], a[200:203], v[64:67]
  v_mfma_f32_16x16x32_bf16 v[68:71], a[32:35], a[204:207], v[68:71]
  s_waitcnt vmcnt(19)
  v_mfma_f32_16x16x32_bf16 v[0:3], a[64:67], a[208:211], v[0:3]
  ds_read_b64_tr_b16 a[0:1], v240 offset:27648
  v_mfma_f32_16x16x32_bf16 v[4:7], a[64:67], a[212:215], v[4:7]
  ds_read_b64_tr_b16 a[2:3], v240 offset:32256
  v_mfma_f32_16x16x32_bf16 v[8:11], a[68:71], a[208:211], v[8:11]
  ds_read_b64_tr_b16 a[4:5], v240 offset:27680
  v_mfma_f32_16x16x32_bf16 v[12:15], a[68:71], a[212:215], v[12:15]
  ds_read_b64_tr_b16 a[6:7], v240 offset:32288
  v_mfma_f32_16x16x32_bf16 v[16:19], a[72:75], a[208:211], v[16:19]
  ds_read_b64_tr_b16 a[8:9], v240 offset:27712
  v_mfma_f32_16x16x32_bf16 v[20:23], a[72:75], a[212:215], v[20:23]
  ds_read_b64_tr_b16 a[10:11], v240 offset:32320
  s_waitcnt lgkmcnt(3)
  v_mfma_f32_16x16x32_bf16 v[24:27], a[76:79], a[208:211], v[24:27]
  ds_read_b64_tr_b16 a[12:13], v240 offset:27744
  v_mfma_f32_16x16x32_bf16 v[28:31], a[76:79], a[212:215], v[28:31]
  ds_read_b64_tr_b16 a[14:15], v240 offset:32352
  v_mfma_f32_16x16x32_bf16 v[32:35], a[80:83], a[208:211], v[32:35]
  ds_read_b64_tr_b16 a[16:17], v240 offset:27776
  v_mfma_f32_16x16x32_bf16 v[36:39], a[80:83], a[212:215], v[36:39]
  ds_read_b64_tr_b16 a[18:19], v240 offset:32384
  v_mfma_f32_16x16x32_bf16 v[40:43], a[84:87], a[208:211], v[40:43]
  ds_read_b64_tr_b16 a[20:21], v240 offset:27808
  v_mfma_f32_16x16x32_bf16 v[44:47], a[84:87], a[212:215], v[44:47]
  ds_read_b64_tr_b16 a[22:23], v240 offset:32416
  v_mfma_f32_16x16x32_bf16 v[48:51], a[88:91], a[208:211], v[48:51]
  ds_read_b64_tr_b16 a[24:25], v240 offset:27840
  v_mfma_f32_16x16x32_bf16 v[52:55], a[88:91], a[212:215], v[52:55]
  ds_read_b64_tr_b16 a[26:27], v240 offset:32448
  v_mfma_f32_16x16x32_bf16 v[56:59], a[92:95], a[208:211], v[56:59]
  ds_read_b64_tr_b16 a[28:29], v240 offset:27872
  v_mfma_f32_16x16x32_bf16 v[60:63], a[92:95], a[212:215], v[60:63]
  ds_read_b64_tr_b16 a[30:31], v240 offset:32480
  ds_read_b64_tr_b16 a[32:33], v240 offset:27904
  ds_read_b64_tr_b16 a[34:35], v240 offset:32512
  v_mfma_f32_16x16x32_bf16 v[64:67], a[96:99], a[208:211], v[64:67]
  v_mfma_f32_16x16x32_bf16 v[68:71], a[96:99], a[212:215], v[68:71]
  s_waitcnt vmcnt(17)
  s_waitcnt vmcnt(8) lgkmcnt(0)
  s_barrier
  v_mfma_f32_16x16x32_bf16 v[0:3], a[0:3], a[216:219], v[0:3]
  ds_read_b64_tr_b16 a[64:65], v241 offset:0
  v_mfma_f32_16x16x32_bf16 v[4:7], a[0:3], a[220:223], v[4:7]
  ds_read_b64_tr_b16 a[66:67], v241 offset:4608
  v_mfma_f32_16x16x32_bf16 v[8:11], a[4:7], a[216:219], v[8:11]
  ds_read_b64_tr_b16 a[68:69], v241 offset:9216
  v_mfma_f32_16x16x32_bf16 v[12:15], a[4:7], a[220:223], v[12:15]
  ds_read_b64_tr_b16 a[70:71], v241 offset:13824
  v_mfma_f32_16x16x32_bf16 v[16:19], a[8:11], a[216:219], v[16:19]
  ds_read_b64_tr_b16 a[72:73], v241 offset:18432
  v_mfma_f32_16x16x32_bf16 v[20:23], a[8:11], a[220:223], v[20:23]
  ds_read_b64_tr_b16 a[74:75], v241 offset:23040
  v_mfma_f32_16x16x32_bf16 v[24:27], a[12:15], a[216:219], v[24:27]
  ds_read_b64_tr_b16 a[76:77], v241 offset:27648
  v_mfma_f32_16x16x32_bf16 v[28:31], a[12:15], a[220:223], v[28:31]
  ds_read_b64_tr_b16 a[78:79], v241 offset:32256
  v_mfma_f32_16x16x32_bf16 v[32:35], a[16:19], a[216:219], v[32:35]
  v_mfma_f32_16x16x32_bf16 v[36:39], a[16:19], a[220:223], v[36:39]
  v_mfma_f32_16x16x32_bf16 v[40:43], a[20:23], a[216:219], v[40:43]
  v_mfma_f32_16x16x32_bf16 v[44:47], a[20:23], a[220:223], v[44:47]
  v_mfma_f32_16x16x32_bf16 v[48:51], a[24:27], a[216:219], v[48:51]
  v_mfma_f32_16x16x32_bf16 v[52:55], a[24:27], a[220:223], v[52:55]
  v_mfma_f32_16x16x32_bf16 v[56:59], a[28:31], a[216:219], v[56:59]
  v_mfma_f32_16x16x32_bf16 v[60:63], a[28:31], a[220:223], v[60:63]
  v_mfma_f32_16x16x32_bf16 v[64:67], a[32:35], a[216:219], v[64:67]
  v_mfma_f32_16x16x32_bf16 v[68:71], a[32:35], a[220:223], v[68:71]
  s_waitcnt vmcnt(0)
  s_waitcnt lgkmcnt(0)
  v_mfma_f32_16x16x32_bf16 v[0:3], a[64:67], a[224:227], v[0:3]
  ds_read_b64_tr_b16 a[80:81], v241 offset:32
  ds_read_b64_tr_b16 a[82:83], v241 offset:4640
  v_mfma_f32_16x16x32_bf16 v[4:7], a[64:67], a[228:231], v[4:7]
  ds_read_b64_tr_b16 a[84:85], v241 offset:9248
  ds_read_b64_tr_b16 a[86:87], v241 offset:13856
  v_mfma_f32_16x16x32_bf16 v[0:3], a[68:71], a[232:235], v[0:3]
  ds_read_b64_tr_b16 a[88:89], v241 offset:18464
  ds_read_b64_tr_b16 a[90:91], v241 offset:23072
  v_mfma_f32_16x16x32_bf16 v[4:7], a[68:71], a[236:239], v[4:7]
  ds_read_b64_tr_b16 a[92:93], v241 offset:27680
  ds_read_b64_tr_b16 a[94:95], v241 offset:32288
  v_mfma_f32_16x16x32_bf16 v[0:3], a[72:75], a[240:243], v[0:3]
  v_mfma_f32_16x16x32_bf16 v[4:7], a[72:75], a[244:247], v[4:7]
  v_mfma_f32_16x16x32_bf16 v[0:3], a[76:79], a[248:251], v[0:3]
  v_mfma_f32_16x16x32_bf16 v[4:7], a[76:79], a[252:255], v[4:7]
  s_waitcnt lgkmcnt(0)
  v_mfma_f32_16x16x32_bf16 v[8:11], a[80:83], a[224:227], v[8:11]
  ds_read_b64_tr_b16 a[64:65], v241 offset:64
  ds_read_b64_tr_b16 a[66:67], v241 offset:4672
  v_mfma_f32_16x16x32_bf16 v[12:15], a[80:83], a[228:231], v[12:15]
  ds_read_b64_tr_b16 a[68:69], v241 offset:9280
  ds_read_b64_tr_b16 a[70:71], v241 offset:13888
  v_mfma_f32_16x16x32_bf16 v[8:11], a[84:87], a[232:235], v[8:11]
  ds_read_b64_tr_b16 a[72:73], v241 offset:18496
  ds_read_b64_tr_b16 a[74:75], v241 offset:23104
  v_mfma_f32_16x16x32_bf16 v[12:15], a[84:87], a[236:239], v[12:15]
  ds_read_b64_tr_b16 a[76:77], v241 offset:27712
  ds_read_b64_tr_b16 a[78:79], v241 offset:32320
  v_mfma_f32_16x16x32_bf16 v[8:11], a[88:91], a[240:243], v[8:11]
  s_add_u32 s70, s32, 0
  v_mfma_f32_16x16x32_bf16 v[12:15], a[88:91], a[244:247], v[12:15]
  buffer_store_dwordx4 v[0:3], v208, s[44:47], s70 offen sc1
  v_mfma_f32_16x16x32_bf16 v[8:11], a[92:95], a[248:251], v[8:11]
  s_add_u32 s71, s33, 9216
  v_mfma_f32_16x16x32_bf16 v[12:15], a[92:95], a[252:255], v[12:15]
  buffer_store_dwordx4 v[4:7], v208, s[44:47], s71 offen sc1
  s_waitcnt lgkmcnt(0)
  v_mfma_f32_16x16x32_bf16 v[16:19], a[64:67], a[224:227], v[16:19]
  ds_read_b64_tr_b16 a[80:81], v241 offset:96
  ds_read_b64_tr_b16 a[82:83], v241 offset:4704
  v_mfma_f32_16x16x32_bf16 v[20:23], a[64:67], a[228:231], v[20:23]
  ds_read_b64_tr_b16 a[84:85], v241 offset:9312
  ds_read_b64_tr_b16 a[86:87], v241 offset:13920
  v_mfma_f32_16x16x32_bf16 v[16:19], a[68:71], a[232:235], v[16:19]
  ds_read_b64_tr_b16 a[88:89], v241 offset:18528
  ds_read_b64_tr_b16 a[90:91], v241 offset:23136
  v_mfma_f32_16x16x32_bf16 v[20:23], a[68:71], a[236:239], v[20:23]
  ds_read_b64_tr_b16 a[92:93], v241 offset:27744
  ds_read_b64_tr_b16 a[94:95], v241 offset:32352
  v_mfma_f32_16x16x32_bf16 v[16:19], a[72:75], a[240:243], v[16:19]
  s_add_u32 s70, s32, 1024
  v_mfma_f32_16x16x32_bf16 v[20:23], a[72:75], a[244:247], v[20:23]
  buffer_store_dwordx4 v[8:11], v208, s[44:47], s70 offen sc1
  v_mfma_f32_16x16x32_bf16 v[16:19], a[76:79], a[248:251], v[16:19]
  s_add_u32 s71, s33, 10240
  v_mfma_f32_16x16x32_bf16 v[20:23], a[76:79], a[252:255], v[20:23]
  buffer_store_dwordx4 v[12:15], v208, s[44:47], s71 offen sc1
  s_waitcnt lgkmcnt(0)
  v_mfma_f32_16x16x32_bf16 v[24:27], a[80:83], a[224:227], v[24:27]
  ds_read_b64_tr_b16 a[64:65], v241 offset:128
  ds_read_b64_tr_b16 a[66:67], v241 offset:4736
  v_mfma_f32_16x16x32_bf16 v[28:31], a[80:83], a[228:231], v[28:31]
  ds_read_b64_tr_b16 a[68:69], v241 offset:9344
  ds_read_b64_tr_b16 a[70:71], v241 offset:13952
  v_mfma_f32_16x16x32_bf16 v[24:27], a[84:87], a[232:235], v[24:27]
  ds_read_b64_tr_b16 a[72:73], v241 offset:18560
  ds_read_b64_tr_b16 a[74:75], v241 offset:23168
  v_mfma_f32_16x16x32_bf16 v[28:31], a[84:87], a[236:239], v[28:31]
  ds_read_b64_tr_b16 a[76:77], v241 offset:27776
  ds_read_b64_tr_b16 a[78:79], v241 offset:32384
  v_mfma_f32_16x16x32_bf16 v[24:27], a[88:91], a[240:243], v[24:27]
  s_add_u32 s70, s32, 2048
  v_mfma_f32_16x16x32_bf16 v[28:31], a[88:91], a[244:247], v[28:31]
  buffer_store_dwordx4 v[16:19], v208, s[44:47], s70 offen sc1
  v_mfma_f32_16x16x32_bf16 v[24:27], a[92:95], a[248:251], v[24:27]
  s_add_u32 s71, s33, 11264
  v_mfma_f32_16x16x32_bf16 v[28:31], a[92:95], a[252:255], v[28:31]
  buffer_store_dwordx4 v[20:23], v208, s[44:47], s71 offen sc1
  s_waitcnt lgkmcnt(0)
  v_mfma_f32_16x16x32_bf16 v[32:35], a[64:67], a[224:227], v[32:35]
  ds_read_b64_tr_b16 a[80:81], v241 offset:160
  ds_read_b64_tr_b16 a[82:83], v241 offset:4768
  v_mfma_f32_16x16x32_bf16 v[36:39], a[64:67], a[228:231], v[36:39]
  ds_read_b64_tr_b16 a[84:85], v241 offset:9376
  ds_read_b64_tr_b16 a[86:87], v241 offset:13984
  v_mfma_f32_16x16x32_bf16 v[32:35], a[68:71], a[232:235], v[32:35]
  ds_read_b64_tr_b16 a[88:89], v241 offset:18592
  ds_read_b64_tr_b16 a[90:91], v241 offset:23200
  v_mfma_f32_16x16x32_bf16 v[36:39], a[68:71], a[236:239], v[36:39]
  ds_read_b64_tr_b16 a[92:93], v241 offset:27808
  ds_read_b64_tr_b16 a[94:95], v241 offset:32416
  v_mfma_f32_16x16x32_bf16 v[32:35], a[72:75], a[240:243], v[32:35]
  s_add_u32 s70, s32, 3072
  v_mfma_f32_16x16x32_bf16 v[36:39], a[72:75], a[244:247], v[36:39]
  buffer_store_dwordx4 v[24:27], v208, s[44:47], s70 offen sc1
  v_mfma_f32_16x16x32_bf16 v[32:35], a[76:79], a[248:251], v[32:35]
  s_add_u32 s71, s33, 12288
  v_mfma_f32_16x16x32_bf16 v[36:39], a[76:79], a[252:255], v[36:39]
  buffer_store_dwordx4 v[28:31], v208, s[44:47], s71 offen sc1
  s_waitcnt lgkmcnt(0)
  v_mfma_f32_16x16x32_bf16 v[40:43], a[80:83], a[224:227], v[40:43]
  ds_read_b64_tr_b16 a[64:65], v241 offset:192
  ds_read_b64_tr_b16 a[66:67], v241 offset:4800
  v_mfma_f32_16x16x32_bf16 v[44:47], a[80:83], a[228:231], v[44:47]
  ds_read_b64_tr_b16 a[68:69], v241 offset:9408
  ds_read_b64_tr_b16 a[70:71], v241 offset:14016
  v_mfma_f32_16x16x32_bf16 v[40:43], a[84:87], a[232:235], v[40:43]
  ds_read_b64_tr_b16 a[72:73], v241 offset:18624
  ds_read_b64_tr_b16 a[74:75], v241 offset:23232
  v_mfma_f32_16x16x32_bf16 v[44:47], a[84:87], a[236:239], v[44:47]
  ds_read_b64_tr_b16 a[76:77], v241 offset:27840
  ds_read_b64_tr_b16 a[78:79], v241 offset:32448
  v_mfma_f32_16x16x32_bf16 v[40:43], a[88:91], a[240:243], v[40:43]
  s_add_u32 s70, s32, 4096
  v_mfma_f32_16x16x32_bf16 v[44:47], a[88:91], a[244:247], v[44:47]
  buffer_store_dwordx4 v[32:35], v208, s[44:47], s70 offen sc1
  v_mfma_f32_16x16x32_bf16 v[40:43], a[92:95], a[248:251], v[40:43]
  s_add_u32 s71, s33, 13312
  v_mfma_f32_16x16x32_bf16 v[44:47], a[92:95], a[252:255], v[44:47]
  buffer_store_dwordx4 v[36:39], v208, s[44:47], s71 offen sc1
  s_waitcnt lgkmcnt(0)
  v_mfma_f32_16x16x32_bf16 v[48:51], a[64:67], a[224:227], v[48:51]
  ds_read_b64_tr_b16 a[80:81], v241 offset:224
  ds_read_b64_tr_b16 a[82:83], v241 offset:4832
  v_mfma_f32_16x16x32_bf16 v[52:55], a[64:67], a[228:231], v[52:55]
  ds_read_b64_tr_b16 a[84:85], v241 offset:9440
  ds_read_b64_tr_b16 a[86:87], v241 offset:14048
  v_mfma_f32_16x16x32_bf16 v[48:51], a[68:71], a[232:235], v[48:51]
  ds_read_b64_tr_b16 a[88:89], v241 offset:18656
  ds_read_b64_tr_b16 a[90:91], v241 offset:23264
  v_mfma_f32_16x16x32_bf16 v[52:55], a[68:71], a[236:239], v[52:55]
  ds_read_b64_tr_b16 a[92:93], v241 offset:27872
  ds_read_b64_tr_b16 a[94:95], v241 offset:32480
  v_mfma_f32_16x16x32_bf16 v[48:51], a[72:75], a[240:243], v[48:51]
  s_add_u32 s70, s34, 5120
  v_mfma_f32_16x16x32_bf16 v[52:55], a[72:75], a[244:247], v[52:55]
  buffer_store_dwordx4 v[40:43], v208, s[44:47], s70 offen sc1
  v_mfma_f32_16x16x32_bf16 v[48:51], a[76:79], a[248:251], v[48:51]
  s_add_u32 s71, s35, 14336
  v_mfma_f32_16x16x32_bf16 v[52:55], a[76:79], a[252:255], v[52:55]
  buffer_store_dwordx4 v[44:47], v208, s[44:47], s71 offen sc1
  s_waitcnt lgkmcnt(0)
  v_mfma_f32_16x16x32_bf16 v[56:59], a[80:83], a[224:227], v[56:59]
  ds_read_b64_tr_b16 a[64:65], v241 offset:256
  ds_read_b64_tr_b16 a[66:67], v241 offset:4864
  v_mfma_f32_16x16x32_bf16 v[60:63], a[80:83], a[228:231], v[60:63]
  ds_read_b64_tr_b16 a[68:69], v241 offset:9472
  ds_read_b64_tr_b16 a[70:71], v241 offset:14080
  v_mfma_f32_16x16x32_bf16 v[56:59], a[84:87], a[232:235], v[56:59]
  ds_read_b64_tr_b16 a[72:73], v241 offset:18688
  ds_read_b64_tr_b16 a[74:75], v241 offset:23296
  v_mfma_f32_16x16x32_bf16 v[60:63], a[84:87], a[236:239], v[60:63]
  ds_read_b64_tr_b16 a[76:77], v241 offset:27904
  ds_read_b64_tr_b16 a[78:79], v241 offset:32512
  v_mfma_f32_16x16x32_bf16 v[56:59], a[88:91], a[240:243], v[56:59]
  s_add_u32 s70, s34, 6144
  v_mfma_f32_16x16x32_bf16 v[60:63], a[88:91], a[244:247], v[60:63]
  buffer_store_dwordx4 v[48:51], v208, s[44:47], s70 offen sc1
  v_mfma_f32_16x16x32_bf16 v[56:59], a[92:95], a[248:251], v[56:59]
  s_add_u32 s71, s35, 15360
  v_mfma_f32_16x16x32_bf16 v[60:63], a[92:95], a[252:255], v[60:63]
  buffer_store_dwordx4 v[52:55], v208, s[44:47], s71 offen sc1
  s_waitcnt lgkmcnt(0)
  v_mfma_f32_16x16x32_bf16 v[64:67], a[64:67], a[224:227], v[64:67]
  v_mfma_f32_16x16x32_bf16 v[68:71], a[64:67], a[228:231], v[68:71]
  v_mfma_f32_16x16x32_bf16 v[64:67], a[68:71], a[232:235], v[64:67]
  v_mfma_f32_16x16x32_bf16 v[68:71], a[68:71], a[236:239], v[68:71]
  v_mfma_f32_16x16x32_bf16 v[64:67], a[72:75], a[240:243], v[64:67]
  s_add_u32 s70, s34, 7168
  v_mfma_f32_16x16x32_bf16 v[68:71], a[72:75], a[244:247], v[68:71]
  buffer_store_dwordx4 v[56:59], v208, s[44:47], s70 offen sc1
  v_mfma_f32_16x16x32_bf16 v[64:67], a[76:79], a[248:251], v[64:67]
  s_add_u32 s71, s35, 16384
  v_mfma_f32_16x16x32_bf16 v[68:71], a[76:79], a[252:255], v[68:71]
  buffer_store_dwordx4 v[60:63], v208, s[44:47], s71 offen sc1
  s_nop 7
  s_add_u32 s70, s34, 8192
  buffer_store_dwordx4 v[64:67], v208, s[44:47], s70 offen sc1
  s_add_u32 s71, s35, 17408
  buffer_store_dwordx4 v[68:71], v208, s[44:47], s71 offen sc1
  s_lshl_b32 s70, s52, 1
  s_add_u32 s70, s70, s57
  s_lshl_b32 s70, s70, 2
  s_add_u32 s70, s70, s58
  s_lshl_b32 s70, s70, 4
  s_add_u32 s70, s70, s54
  s_lshl_b32 s70, s70, 7
  s_add_u32 s70, s70, 42074112
  s_lshl_b32 s71, s55, 9
  s_add_u32 s71, s71, s70
  v_mov_b32 v234, s71
  v_lshrrev_b32 v235, 4, v208
  v_xor_b32 v236, 1, v235
  v_cmp_eq_u32 vcc, s55, v235
  s_nop 1
  v_cndmask_b32 v235, v235, v236, vcc
  v_lshlrev_b32 v235, 9, v235
  v_add_u32 v235, s70, v235
  v_bfe_u32 v242, v208, 4, 4
  v_lshrrev_b32 v243, 8, v208
  s_and_b32 s70, s55, 1
  s_lshl_b32 s73, s54, 6
  s_lshl_b32 s64, s57, 5
  s_add_u32 s73, s73, s64
  s_lshl_b32 s64, s70, 4
  s_add_u32 s73, s73, s64
  v_add_u32 v242, s73, v242
  v_mul_u32_u24 v242, 1152, v242
  v_lshl_add_u32 v242, v243, 3, v242
  s_mul_i32 s77, s54, 18432
  s_mul_i32 s4, s58, 288
  s_waitcnt vmcnt(0)
  s_mov_b64 exec, 0xf
  global_load_dwordx2 v[244:245], v235, s[18:19] sc1
  s_mov_b64 exec, 1
  global_store_dwordx2 v234, v[232:233], s[18:19] sc1
  s_mov_b64 exec, -1
L_fin_v0:
  s_cmp_lg_u32 s55, 0
  s_cbranch_scc1 L_fin_v1
  s_mov_b32 s64, 1
  s_mov_b32 s72, 0
  s_mov_b64 exec, 0xf
  s_waitcnt vmcnt(1)
  s_branch L_pq0
L_pp0:
  s_mov_b64 exec, 0xf
  global_load_dwordx2 v[244:245], v235, s[18:19] sc1
  s_waitcnt vmcnt(0)
L_pq0:
  v_cmp_eq_u32 vcc, v244, v232
  v_cmp_eq_u32 s[70:71], v245, v233
  s_and_b64 vcc, vcc, s[70:71]
  s_mov_b64 exec, -1
  s_andn2_b32 s70, vcc_lo, s64
  s_or_b32 s64, s64, s70
  s_bitcmp1_b32 s70, 1
  s_cbranch_scc0 L_pp0_1
  s_add_u32 s73, s77, 73728
  buffer_load_dwordx4 v[80:83], v208, s[44:47], s73 offen sc1
  s_add_u32 s73, s77, 74752
  buffer_load_dwordx4 v[84:87], v208, s[44:47], s73 offen sc1
  s_add_u32 s73, s77, 75776
  buffer_load_dwordx4 v[88:91], v208, s[44:47], s73 offen sc1
  s_add_u32 s73, s77, 76800
  buffer_load_dwordx4 v[92:95], v208, s[44:47], s73 offen sc1
  s_add_u32 s73, s77, 77824
  buffer_load_dwordx4 v[96:99], v208, s[44:47], s73 offen sc1
L_pp0_1:
  s_bitcmp1_b32 s70, 2
  s_cbranch_scc0 L_pp0_2
  s_add_u32 s73, s77, 147456
  buffer_load_dwordx4 v[100:103], v208, s[44:47], s73 offen sc1
  s_add_u32 s73, s77, 148480
  buffer_load_dwordx4 v[104:107], v208, s[44:47], s73 offen sc1
  s_add_u32 s73, s77, 149504
  buffer_load_dwordx4 v[108:111], v208, s[44:47], s73 offen sc1
  s_add_u32 s73, s77, 150528
  buffer_load_dwordx4 v[112:115], v208, s[44:47], s73 offen sc1
  s_add_u32 s73, s77, 151552
  buffer_load_dwordx4 v[116:119], v208, s[44:47], s73 offen sc1
L_pp0_2:
  s_bitcmp1_b32 s70, 3
  s_cbranch_scc0 L_pp0_3
  s_add_u32 s73, s77, 221184
  buffer_load_dwordx4 v[120:123], v208, s[44:47], s73 offen sc1
  s_add_u32 s73, s77, 222208
  buffer_load_dwordx4 v[124:127], v208, s[44:47], s73 offen sc1
  s_add_u32 s73, s77, 223232
  buffer_load_dwordx4 v[128:131], v208, s[44:47], s73 offen sc1
  s_add_u32 s73, s77, 224256
  buffer_load_dwordx4 v[132:135], v208, s[44:47], s73 offen sc1
  s_add_u32 s73, s77, 225280
  buffer_load_dwordx4 v[136:139], v208, s[44:47], s73 offen sc1
L_pp0_3:
  s_add_u32 s72, s72, 1
  s_cmp_eq_u32 s64, 15
  s_cbranch_scc1 L_ppd0
  s_cmp_lt_u32 s72, 0x40000
  s_cbranch_scc1 L_pp0
L_ppd0:
  s_waitcnt vmcnt(0)
  v_add_f32 v0, v0, v80
  v_add_f32 v100, v100, v120
  v_add_f32 v1, v1, v81
  v_add_f32 v101, v101, v121
  v_add_f32 v2, v2, v82
  v_add_f32 v102, v102, v122
  v_add_f32 v3, v3, v83
  v_add_f32 v103, v103, v123
  v_add_f32 v0, v0, v100
  v_add_f32 v1, v1, v101
  v_add_f32 v2, v2, v102
  v_add_f32 v3, v3, v103
  v_cvt_pk_bf16_f32 v144, v0, v1
  v_cvt_pk_bf16_f32 v145, v2, v3
  buffer_store_dwordx2 v[144:145], v242, s[48:51], s4 offen offset:0 sc1
  v_add_f32 v8, v8, v84
  v_add_f32 v104, v104, v124
  v_add_f32 v9, v9, v85
  v_add_f32 v105, v105, v125
  v_add_f32 v10, v10, v86
  v_add_f32 v106, v106, v126
  v_add_f32 v11, v11, v87
  v_add_f32 v107, v107, v127
  v_add_f32 v8, v8, v104
  v_add_f32 v9, v9, v105
  v_add_f32 v10, v10, v106
  v_add_f32 v11, v11, v107
  v_cvt_pk_bf16_f32 v146, v8, v9
  v_cvt_pk_bf16_f32 v147, v10, v11
  buffer_store_dwordx2 v[146:147], v242, s[48:51], s4 offen offset:32 sc1
  v_add_f32 v16, v16, v88
  v_add_f32 v108, v108, v128
  v_add_f32 v17, v17, v89
  v_add_f32 v109, v109, v129
  v_add_f32 v18, v18, v90
  v_add_f32 v110, v110, v130
  v_add_f32 v19, v19, v91
  v_add_f32 v111, v111, v131
  v_add_f32 v16, v16, v108
  v_add_f32 v17, v17, v109
  v_add_f32 v18, v18, v110
  v_add_f32 v19, v19, v111
  v_cvt_pk_bf16_f32 v148, v16, v17
  v_cvt_pk_bf16_f32 v149, v18, v19
  buffer_store_dwordx2 v[148:149], v242, s[48:51], s4 offen offset:64 sc1
  v_add_f32 v24, v24, v92
  v_add_f32 v112, v112, v132
  v_add_f32 v25, v25, v93
  v_add_f32 v113, v113, v133
  v_add_f32 v26, v26, v94
  v_add_f32 v114, v114, v134
  v_add_f32 v27, v27, v95
  v_add_f32 v115, v115, v135
  v_add_f32 v24, v24, v112
  v_add_f32 v25, v25, v113
  v_add_f32 v26, v26, v114
  v_add_f32 v27, v27, v115
  v_cvt_pk_bf16_f32 v150, v24, v25
  v_cvt_pk_bf16_f32 v151, v26, v27
  buffer_store_dwordx2 v[150:151], v242, s[48:51], s4 offen offset:96 sc1
  v_add_f32 v32, v32, v96
  v_add_f32 v116, v116, v136
  v_add_f32 v33, v33, v97
  v_add_f32 v117, v117, v137
  v_add_f32 v34, v34, v98
  v_add_f32 v118, v118, v138
  v_add_f32 v35, v35, v99
  v_add_f32 v119, v119, v139
  v_add_f32 v32, v32, v116
  v_add_f32 v33, v33, v117
  v_add_f32 v34, v34, v118
  v_add_f32 v35, v35, v119
  v_cvt_pk_bf16_f32 v152, v32, v33
  v_cvt_pk_bf16_f32 v153, v34, v35
  buffer_store_dwordx2 v[152:153], v242, s[48:51], s4 offen offset:128 sc1
  s_branch L_fin
L_fin_v1:
  s_cmp_lg_u32 s55, 1
  s_cbranch_scc1 L_fin_v2
  s_mov_b32 s64, 2
  s_mov_b32 s72, 0
  s_mov_b64 exec, 0xf
  s_waitcnt vmcnt(1)
  s_branch L_pq1
L_pp1:
  s_mov_b64 exec, 0xf
  global_load_dwordx2 v[244:245], v235, s[18:19] sc1
  s_waitcnt vmcnt(0)
L_pq1:
  v_cmp_eq_u32 vcc, v244, v232
  v_cmp_eq_u32 s[70:71], v245, v233
  s_and_b64 vcc, vcc, s[70:71]
  s_mov_b64 exec, -1
  s_andn2_b32 s70, vcc_lo, s64
  s_or_b32 s64, s64, s70
  s_bitcmp1_b32 s70, 0
  s_cbranch_scc0 L_pp1_0
  s_add_u32 s73, s77, 9216
  buffer_load_dwordx4 v[80:83], v208, s[44:47], s73 offen sc1
  s_add_u32 s73, s77, 10240
  buffer_load_dwordx4 v[84:87], v208, s[44:47], s73 offen sc1
  s_add_u32 s73, s77, 11264
  buffer_load_dwordx4 v[88:91], v208, s[44:47], s73 offen sc1
  s_add_u32 s73, s77, 12288
  buffer_load_dwordx4 v[92:95], v208, s[44:47], s73 offen sc1
  s_add_u32 s73, s77, 13312
  buffer_load_dwordx4 v[96:99], v208, s[44:47], s73 offen sc1
L_pp1_0:
  s_bitcmp1_b32 s70, 2
  s_cbranch_scc0 L_pp1_2
  s_add_u32 s73, s77, 156672
  buffer_load_dwordx4 v[100:103], v208, s[44:47], s73 offen sc1
  s_add_u32 s73, s77, 157696
  buffer_load_dwordx4 v[104:107], v208, s[44:47], s73 offen sc1
  s_add_u32 s73, s77, 158720
  buffer_load_dwordx4 v[108:111], v208, s[44:47], s73 offen sc1
  s_add_u32 s73, s77, 159744
  buffer_load_dwordx4 v[112:115], v208, s[44:47], s73 offen sc1
  s_add_u32 s73, s77, 160768
  buffer_load_dwordx4 v[116:119], v208, s[44:47], s73 offen sc1
L_pp1_2:
  s_bitcmp1_b32 s70, 3
  s_cbranch_scc0 L_pp1_3
  s_add_u32 s73, s77, 230400
  buffer_load_dwordx4 v[120:123], v208, s[44:47], s73 offen sc1
  s_add_u32 s73, s77, 231424
  buffer_load_dwordx4 v[124:127], v208, s[44:47], s73 offen sc1
  s_add_u32 s73, s77, 232448
  buffer_load_dwordx4 v[128:131], v208, s[44:47], s73 offen sc1
  s_add_u32 s73, s77, 233472
  buffer_load_dwordx4 v[132:135], v208, s[44:47], s73 offen sc1
  s_add_u32 s73, s77, 234496
  buffer_load_dwordx4 v[136:139], v208, s[44:47], s73 offen sc1
L_pp1_3:
  s_add_u32 s72, s72, 1
  s_cmp_eq_u32 s64, 15
  s_cbranch_scc1 L_ppd1
  s_cmp_lt_u32 s72, 0x40000
  s_cbranch_scc1 L_pp1
L_ppd1:
  s_waitcnt vmcnt(0)
  v_add_f32 v4, v4, v80
  v_add_f32 v100, v100, v120
  v_add_f32 v5, v5, v81
  v_add_f32 v101, v101, v121
  v_add_f32 v6, v6, v82
  v_add_f32 v102, v102, v122
  v_add_f32 v7, v7, v83
  v_add_f32 v103, v103, v123
  v_add_f32 v4, v4, v100
  v_add_f32 v5, v5, v101
  v_add_f32 v6, v6, v102
  v_add_f32 v7, v7, v103
  v_cvt_pk_bf16_f32 v144, v4, v5
  v_cvt_pk_bf16_f32 v145, v6, v7
  buffer_store_dwordx2 v[144:145], v242, s[48:51], s4 offen offset:0 sc1
  v_add_f32 v12, v12, v84
  v_add_f32 v104, v104, v124
  v_add_f32 v13, v13, v85
  v_add_f32 v105, v105, v125
  v_add_f32 v14, v14, v86
  v_add_f32 v106, v106, v126
  v_add_f32 v15, v15, v87
  v_add_f32 v107, v107, v127
  v_add_f32 v12, v12, v104
  v_add_f32 v13, v13, v105
  v_add_f32 v14, v14, v106
  v_add_f32 v15, v15, v107
  v_cvt_pk_bf16_f32 v146, v12, v13
  v_cvt_pk_bf16_f32 v147, v14, v15
  buffer_store_dwordx2 v[146:147], v242, s[48:51], s4 offen offset:32 sc1
  v_add_f32 v20, v20, v88
  v_add_f32 v108, v108, v128
  v_add_f32 v21, v21, v89
  v_add_f32 v109, v109, v129
  v_add_f32 v22, v22, v90
  v_add_f32 v110, v110, v130
  v_add_f32 v23, v23, v91
  v_add_f32 v111, v111, v131
  v_add_f32 v20, v20, v108
  v_add_f32 v21, v21, v109
  v_add_f32 v22, v22, v110
  v_add_f32 v23, v23, v111
  v_cvt_pk_bf16_f32 v148, v20, v21
  v_cvt_pk_bf16_f32 v149, v22, v23
  buffer_store_dwordx2 v[148:149], v242, s[48:51], s4 offen offset:64 sc1
  v_add_f32 v28, v28, v92
  v_add_f32 v112, v112, v132
  v_add_f32 v29, v29, v93
  v_add_f32 v113, v113, v133
  v_add_f32 v30, v30, v94
  v_add_f32 v114, v114, v134
  v_add_f32 v31, v31, v95
  v_add_f32 v115, v115, v135
  v_add_f32 v28, v28, v112
  v_add_f32 v29, v29, v113
  v_add_f32 v30, v30, v114
  v_add_f32 v31, v31, v115
  v_cvt_pk_bf16_f32 v150, v28, v29
  v_cvt_pk_bf16_f32 v151, v30, v31
  buffer_store_dwordx2 v[150:151], v242, s[48:51], s4 offen offset:96 sc1
  v_add_f32 v36, v36, v96
  v_add_f32 v116, v116, v136
  v_add_f32 v37, v37, v97
  v_add_f32 v117, v117, v137
  v_add_f32 v38, v38, v98
  v_add_f32 v118, v118, v138
  v_add_f32 v39, v39, v99
  v_add_f32 v119, v119, v139
  v_add_f32 v36, v36, v116
  v_add_f32 v37, v37, v117
  v_add_f32 v38, v38, v118
  v_add_f32 v39, v39, v119
  v_cvt_pk_bf16_f32 v152, v36, v37
  v_cvt_pk_bf16_f32 v153, v38, v39
  buffer_store_dwordx2 v[152:153], v242, s[48:51], s4 offen offset:128 sc1
  s_branch L_fin
L_fin_v2:
  s_cmp_lg_u32 s55, 2
  s_cbranch_scc1 L_fin_v3
  s_mov_b32 s64, 4
  s_mov_b32 s72, 0
  s_mov_b64 exec, 0xf
  s_waitcnt vmcnt(1)
  s_branch L_pq2
L_pp2:
  s_mov_b64 exec, 0xf
  global_load_dwordx2 v[244:245], v235, s[18:19] sc1
  s_waitcnt vmcnt(0)
L_pq2:
  v_cmp_eq_u32 vcc, v244, v232
  v_cmp_eq_u32 s[70:71], v245, v233
  s_and_b64 vcc, vcc, s[70:71]
  s_mov_b64 exec, -1
  s_andn2_b32 s70, vcc_lo, s64
  s_or_b32 s64, s64, s70
  s_bitcmp1_b32 s70, 0
  s_cbranch_scc0 L_pp2_0
  s_add_u32 s73, s77, 5120
  buffer_load_dwordx4 v[80:83], v208, s[44:47], s73 offen sc1
  s_add_u32 s73, s77, 6144
  buffer_load_dwordx4 v[84:87], v208, s[44:47], s73 offen sc1
  s_add_u32 s73, s77, 7168
  buffer_load_dwordx4 v[88:91], v208, s[44:47], s73 offen sc1
  s_add_u32 s73, s77, 8192
  buffer_load_dwordx4 v[92:95], v208, s[44:47], s73 offen sc1
L_pp2_0:
  s_bitcmp1_b32 s70, 1
  s_cbranch_scc0 L_pp2_1
  s_add_u32 s73, s77, 78848
  buffer_load_dwordx4 v[100:103], v208, s[44:47], s73 offen sc1
  s_add_u32 s73, s77, 79872
  buffer_load_dwordx4 v[104:107], v208, s[44:47], s73 offen sc1
  s_add_u32 s73, s77, 80896
  buffer_load_dwordx4 v[108:111], v208, s[44:47], s73 offen sc1
  s_add_u32 s73, s77, 81920
  buffer_load_dwordx4 v[112:115], v208, s[44:47], s73 offen sc1
L_pp2_1:
  s_bitcmp1_b32 s70, 3
  s_cbranch_scc0 L_pp2_3
  s_add_u32 s73, s77, 226304
  buffer_load_dwordx4 v[120:123], v208, s[44:47], s73 offen sc1
  s_add_u32 s73, s77, 227328
  buffer_load_dwordx4 v[124:127], v208, s[44:47], s73 offen sc1
  s_add_u32 s73, s77, 228352
  buffer_load_dwordx4 v[128:131], v208, s[44:47], s73 offen sc1
  s_add_u32 s73, s77, 229376
  buffer_load_dwordx4 v[132:135], v208, s[44:47], s73 offen sc1
L_pp2_3:
  s_add_u32 s72, s72, 1
  s_cmp_eq_u32 s64, 15
  s_cbranch_scc1 L_ppd2
  s_cmp_lt_u32 s72, 0x40000
  s_cbranch_scc1 L_pp2
L_ppd2:
  s_waitcnt vmcnt(0)
  v_add_f32 v40, v40, v80
  v_add_f32 v100, v100, v120
  v_add_f32 v41, v41, v81
  v_add_f32 v101, v101, v121
  v_add_f32 v42, v42, v82
  v_add_f32 v102, v102, v122
  v_add_f32 v43, v43, v83
  v_add_f32 v103, v103, v123
  v_add_f32 v40, v40, v100
  v_add_f32 v41, v41, v101
  v_add_f32 v42, v42, v102
  v_add_f32 v43, v43, v103
  v_cvt_pk_bf16_f32 v144, v40, v41
  v_cvt_pk_bf16_f32 v145, v42, v43
  buffer_store_dwordx2 v[144:145], v242, s[48:51], s4 offen offset:160 sc1
  v_add_f32 v48, v48, v84
  v_add_f32 v104, v104, v124
  v_add_f32 v49, v49, v85
  v_add_f32 v105, v105, v125
  v_add_f32 v50, v50, v86
  v_add_f32 v106, v106, v126
  v_add_f32 v51, v51, v87
  v_add_f32 v107, v107, v127
  v_add_f32 v48, v48, v104
  v_add_f32 v49, v49, v105
  v_add_f32 v50, v50, v106
  v_add_f32 v51, v51, v107
  v_cvt_pk_bf16_f32 v146, v48, v49
  v_cvt_pk_bf16_f32 v147, v50, v51
  buffer_store_dwordx2 v[146:147], v242, s[48:51], s4 offen offset:192 sc1
  v_add_f32 v56, v56, v88
  v_add_f32 v108, v108, v128
  v_add_f32 v57, v57, v89
  v_add_f32 v109, v109, v129
  v_add_f32 v58, v58, v90
  v_add_f32 v110, v110, v130
  v_add_f32 v59, v59, v91
  v_add_f32 v111, v111, v131
  v_add_f32 v56, v56, v108
  v_add_f32 v57, v57, v109
  v_add_f32 v58, v58, v110
  v_add_f32 v59, v59, v111
  v_cvt_pk_bf16_f32 v148, v56, v57
  v_cvt_pk_bf16_f32 v149, v58, v59
  buffer_store_dwordx2 v[148:149], v242, s[48:51], s4 offen offset:224 sc1
  v_add_f32 v64, v64, v92
  v_add_f32 v112, v112, v132
  v_add_f32 v65, v65, v93
  v_add_f32 v113, v113, v133
  v_add_f32 v66, v66, v94
  v_add_f32 v114, v114, v134
  v_add_f32 v67, v67, v95
  v_add_f32 v115, v115, v135
  v_add_f32 v64, v64, v112
  v_add_f32 v65, v65, v113
  v_add_f32 v66, v66, v114
  v_add_f32 v67, v67, v115
  v_cvt_pk_bf16_f32 v150, v64, v65
  v_cvt_pk_bf16_f32 v151, v66, v67
  buffer_store_dwordx2 v[150:151], v242, s[48:51], s4 offen offset:256 sc1
  s_branch L_fin
L_fin_v3:
  s_mov_b32 s64, 8
  s_mov_b32 s72, 0
  s_mov_b64 exec, 0xf
  s_waitcnt vmcnt(1)
  s_branch L_pq3
L_pp3:
  s_mov_b64 exec, 0xf
  global_load_dwordx2 v[244:245], v235, s[18:19] sc1
  s_waitcnt vmcnt(0)
L_pq3:
  v_cmp_eq_u32 vcc, v244, v232
  v_cmp_eq_u32 s[70:71], v245, v233
  s_and_b64 vcc, vcc, s[70:71]
  s_mov_b64 exec, -1
  s_andn2_b32 s70, vcc_lo, s64
  s_or_b32 s64, s64, s70
  s_bitcmp1_b32 s70, 0
  s_cbranch_scc0 L_pp3_0
  s_add_u32 s73, s77, 14336
  buffer_load_dwordx4 v[80:83], v208, s[44:47], s73 offen sc1
  s_add_u32 s73, s77, 15360
  buffer_load_dwordx4 v[84:87], v208, s[44:47], s73 offen sc1
  s_add_u32 s73, s77, 16384
  buffer_load_dwordx4 v[88:91], v208, s[44:47], s73 offen sc1
  s_add_u32 s73, s77, 17408
  buffer_load_dwordx4 v[92:95], v208, s[44:47], s73 offen sc1
L_pp3_0:
  s_bitcmp1_b32 s70, 1
  s_cbranch_scc0 L_pp3_1
  s_add_u32 s73, s77, 88064
  buffer_load_dwordx4 v[100:103], v208, s[44:47], s73 offen sc1
  s_add_u32 s73, s77, 89088
  buffer_load_dwordx4 v[104:107], v208, s[44:47], s73 offen sc1
  s_add_u32 s73, s77, 90112
  buffer_load_dwordx4 v[108:111], v208, s[44:47], s73 offen sc1
  s_add_u32 s73, s77, 91136
  buffer_load_dwordx4 v[112:115], v208, s[44:47], s73 offen sc1
L_pp3_1:
  s_bitcmp1_b32 s70, 2
  s_cbranch_scc0 L_pp3_2
  s_add_u32 s73, s77, 161792
  buffer_load_dwordx4 v[120:123], v208, s[44:47], s73 offen sc1
  s_add_u32 s73, s77, 162816
  buffer_load_dwordx4 v[124:127], v208, s[44:47], s73 offen sc1
  s_add_u32 s73, s77, 163840
  buffer_load_dwordx4 v[128:131], v208, s[44:47], s73 offen sc1
  s_add_u32 s73, s77, 164864
  buffer_load_dwordx4 v[132:135], v208, s[44:47], s73 offen sc1
L_pp3_2:
  s_add_u32 s72, s72, 1
  s_cmp_eq_u32 s64, 15
  s_cbranch_scc1 L_ppd3
  s_cmp_lt_u32 s72, 0x40000
  s_cbranch_scc1 L_pp3
L_ppd3:
  s_waitcnt vmcnt(0)
  v_add_f32 v44, v44, v80
  v_add_f32 v100, v100, v120
  v_add_f32 v45, v45, v81
  v_add_f32 v101, v101, v121
  v_add_f32 v46, v46, v82
  v_add_f32 v102, v102, v122
  v_add_f32 v47, v47, v83
  v_add_f32 v103, v103, v123
  v_add_f32 v44, v44, v100
  v_add_f32 v45, v45, v101
  v_add_f32 v46, v46, v102
  v_add_f32 v47, v47, v103
  v_cvt_pk_bf16_f32 v144, v44, v45
  v_cvt_pk_bf16_f32 v145, v46, v47
  buffer_store_dwordx2 v[144:145], v242, s[48:51], s4 offen offset:160 sc1
  v_add_f32 v52, v52, v84
  v_add_f32 v104, v104, v124
  v_add_f32 v53, v53, v85
  v_add_f32 v105, v105, v125
  v_add_f32 v54, v54, v86
  v_add_f32 v106, v106, v126
  v_add_f32 v55, v55, v87
  v_add_f32 v107, v107, v127
  v_add_f32 v52, v52, v104
  v_add_f32 v53, v53, v105
  v_add_f32 v54, v54, v106
  v_add_f32 v55, v55, v107
  v_cvt_pk_bf16_f32 v146, v52, v53
  v_cvt_pk_bf16_f32 v147, v54, v55
  buffer_store_dwordx2 v[146:147], v242, s[48:51], s4 offen offset:192 sc1
  v_add_f32 v60, v60, v88
  v_add_f32 v108, v108, v128
  v_add_f32 v61, v61, v89
  v_add_f32 v109, v109, v129
  v_add_f32 v62, v62, v90
  v_add_f32 v110, v110, v130
  v_add_f32 v63, v63, v91
  v_add_f32 v111, v111, v131
  v_add_f32 v60, v60, v108
  v_add_f32 v61, v61, v109
  v_add_f32 v62, v62, v110
  v_add_f32 v63, v63, v111
  v_cvt_pk_bf16_f32 v148, v60, v61
  v_cvt_pk_bf16_f32 v149, v62, v63
  buffer_store_dwordx2 v[148:149], v242, s[48:51], s4 offen offset:224 sc1
  v_add_f32 v68, v68, v92
  v_add_f32 v112, v112, v132
  v_add_f32 v69, v69, v93
  v_add_f32 v113, v113, v133
  v_add_f32 v70, v70, v94
  v_add_f32 v114, v114, v134
  v_add_f32 v71, v71, v95
  v_add_f32 v115, v115, v135
  v_add_f32 v68, v68, v112
  v_add_f32 v69, v69, v113
  v_add_f32 v70, v70, v114
  v_add_f32 v71, v71, v115
  v_cvt_pk_bf16_f32 v150, v68, v69
  v_cvt_pk_bf16_f32 v151, v70, v71
  buffer_store_dwordx2 v[150:151], v242, s[48:51], s4 offen offset:256 sc1
L_fin:
L_end:
  s_endpgm
L_redo:
  s_waitcnt vmcnt(0) lgkmcnt(0)
  s_barrier
  v_mov_b32 v246, 0x3f803f80
  v_accvgpr_write_b32 a228, v246
  v_accvgpr_write_b32 a229, v246
  v_accvgpr_write_b32 a230, v246
  v_accvgpr_write_b32 a231, v246
  v_mov_b32 v242, 0xff800000
  v_mov_b32 v243, 0xff800000
  v_mov_b32 v244, 0xff800000
  v_mov_b32 v245, 0xff800000
  s_mov_b32 s67, s68
  s_mov_b32 s64, 32
L_redo_max:
  s_mov_b32 m0, s68
  s_nop 0
  buffer_load_dwordx4 v196, s[28:31], s67 offen offset:0 nt lds
  buffer_load_dwordx4 v197, s[28:31], s67 offen offset:1024 nt lds
  s_add_u32 s67, s67, 8192
  s_waitcnt vmcnt(0)
  s_barrier
  ds_read_b128 a[64:67], v184 offset:0
  ds_read_b128 a[68:71], v185 offset:0
  ds_read_b128 a[72:75], v186 offset:0
  ds_read_b128 a[76:79], v187 offset:0
  ds_read_b128 a[80:83], v184 offset:4096
  ds_read_b128 a[84:87], v185 offset:4096
  ds_read_b128 a[88:91], v186 offset:4096
  ds_read_b128 a[92:95], v187 offset:4096
  s_waitcnt lgkmcnt(0)
  v_mfma_f32_16x16x32_bf16 v[0:3], a[64:67], a[0:3], 0
  v_mfma_f32_16x16x32_bf16 v[0:3], a[68:71], a[4:7], v[0:3]
  v_mfma_f32_16x16x32_bf16 v[0:3], a[72:75], a[8:11], v[0:3]
  v_mfma_f32_16x16x32_bf16 v[0:3], a[76:79], a[12:15], v[0:3]
  v_mfma_f32_16x16x32_bf16 v[4:7], a[80:83], a[0:3], 0
  v_mfma_f32_16x16x32_bf16 v[4:7], a[84:87], a[4:7], v[4:7]
  v_mfma_f32_16x16x32_bf16 v[4:7], a[88:91], a[8:11], v[4:7]
  v_mfma_f32_16x16x32_bf16 v[4:7], a[92:95], a[12:15], v[4:7]
  v_mfma_f32_16x16x32_bf16 v[8:11], a[64:67], a[16:19], 0
  v_mfma_f32_16x16x32_bf16 v[8:11], a[68:71], a[20:23], v[8:11]
  v_mfma_f32_16x16x32_bf16 v[8:11], a[72:75], a[24:27], v[8:11]
  v_mfma_f32_16x16x32_bf16 v[8:11], a[76:79], a[28:31], v[8:11]
  v_mfma_f32_16x16x32_bf16 v[12:15], a[80:83], a[16:19], 0
  v_mfma_f32_16x16x32_bf16 v[12:15], a[84:87], a[20:23], v[12:15]
  v_mfma_f32_16x16x32_bf16 v[12:15], a[88:91], a[24:27], v[12:15]
  v_mfma_f32_16x16x32_bf16 v[12:15], a[92:95], a[28:31], v[12:15]
  v_mfma_f32_16x16x32_bf16 v[16:19], a[64:67], a[32:35], 0
  v_mfma_f32_16x16x32_bf16 v[16:19], a[68:71], a[36:39], v[16:19]
  v_mfma_f32_16x16x32_bf16 v[16:19], a[72:75], a[40:43], v[16:19]
  v_mfma_f32_16x16x32_bf16 v[16:19], a[76:79], a[44:47], v[16:19]
  v_mfma_f32_16x16x32_bf16 v[20:23], a[80:83], a[32:35], 0
  v_mfma_f32_16x16x32_bf16 v[20:23], a[84:87], a[36:39], v[20:23]
  v_mfma_f32_16x16x32_bf16 v[20:23], a[88:91], a[40:43], v[20:23]
  v_mfma_f32_16x16x32_bf16 v[20:23], a[92:95], a[44:47], v[20:23]
  v_mfma_f32_16x16x32_bf16 v[24:27], a[64:67], a[48:51], 0
  v_mfma_f32_16x16x32_bf16 v[24:27], a[68:71], a[52:55], v[24:27]
  v_mfma_f32_16x16x32_bf16 v[24:27], a[72:75], a[56:59], v[24:27]
  v_mfma_f32_16x16x32_bf16 v[24:27], a[76:79], a[60:63], v[24:27]
  v_mfma_f32_16x16x32_bf16 v[28:31], a[80:83], a[48:51], 0
  v_mfma_f32_16x16x32_bf16 v[28:31], a[84:87], a[52:55], v[28:31]
  v_mfma_f32_16x16x32_bf16 v[28:31], a[88:91], a[56:59], v[28:31]
  v_mfma_f32_16x16x32_bf16 v[28:31], a[92:95], a[60:63], v[28:31]
  s_nop 7
  s_barrier
  v_max3_f32 v242, v242, v0, v1
  v_max3_f32 v242, v242, v2, v3
  v_max3_f32 v242, v242, v4, v5
  v_max3_f32 v242, v242, v6, v7
  v_max3_f32 v243, v243, v8, v9
  v_max3_f32 v243, v243, v10, v11
  v_max3_f32 v243, v243, v12, v13
  v_max3_f32 v243, v243, v14, v15
  v_max3_f32 v244, v244, v16, v17
  v_max3_f32 v244, v244, v18, v19
  v_max3_f32 v244, v244, v20, v21
  v_max3_f32 v244, v244, v22, v23
  v_max3_f32 v245, v245, v24, v25
  v_max3_f32 v245, v245, v26, v27
  v_max3_f32 v245, v245, v28, v29
  v_max3_f32 v245, v245, v30, v31
  s_sub_u32 s64, s64, 1
  s_cmp_lg_u32 s64, 0
  s_cbranch_scc1 L_redo_max
  v_mov_b32 v144, v242
  v_mov_b32 v145, v242
  v_mov_b32 v146, v243
  v_mov_b32 v147, v243
  v_mov_b32 v148, v244
  v_mov_b32 v149, v244
  v_mov_b32 v150, v245
  v_mov_b32 v151, v245
  s_nop 1
  v_permlane32_swap_b32 v144, v145
  v_permlane32_swap_b32 v146, v147
  v_permlane32_swap_b32 v148, v149
  v_permlane32_swap_b32 v150, v151
  v_max_f32 v144, v144, v145
  v_max_f32 v146, v146, v147
  v_max_f32 v148, v148, v149
  v_max_f32 v150, v150, v151
  v_mov_b32 v145, v144
  v_mov_b32 v147, v146
  v_mov_b32 v149, v148
  v_mov_b32 v151, v150
  s_nop 1
  v_permlane16_swap_b32 v144, v145
  v_permlane16_swap_b32 v146, v147
  v_permlane16_swap_b32 v148, v149
  v_permlane16_swap_b32 v150, v151
  v_max_f32 v144, v144, v145
  v_max_f32 v146, v146, v147
  v_max_f32 v148, v148, v149
  v_max_f32 v150, v150, v151
  v_sub_f32 v168, 0, v144
  v_sub_f32 v169, 0, v144
  v_sub_f32 v170, 0, v144
  v_sub_f32 v171, 0, v144
  v_sub_f32 v172, 0, v146
  v_sub_f32 v173, 0, v146
  v_sub_f32 v174, 0, v146
  v_sub_f32 v175, 0, v146
  v_sub_f32 v176, 0, v148
  v_sub_f32 v177, 0, v148
  v_sub_f32 v178, 0, v148
  v_sub_f32 v179, 0, v148
  v_sub_f32 v180, 0, v150
  v_sub_f32 v181, 0, v150
  v_sub_f32 v182, 0, v150
  v_sub_f32 v183, 0, v150
  s_mov_b32 s67, s68
  s_add_u32 m0, s68, 0
  s_nop 0
  buffer_load_dwordx4 v196, s[28:31], s67 offen offset:0 nt lds
  buffer_load_dwordx4 v197, s[28:31], s67 offen offset:1024 nt lds
  s_mov_b32 s69, s67
  s_add_u32 s67, s67, 8192
  s_add_u32 m0, s68, 16384
  s_nop 0
  buffer_load_dwordx4 v196, s[28:31], s67 offen offset:0 nt lds
  buffer_load_dwordx4 v197, s[28:31], s67 offen offset:1024 nt lds
  s_add_u32 m0, s68, 24576
  s_nop 0
  buffer_load_dwordx4 v196, s[32:35], s69 offen offset:0 nt lds
  buffer_load_dwordx4 v197, s[32:35], s69 offen offset:1024 nt lds
  s_mov_b32 s69, s67
  s_add_u32 s67, s67, 8192
  s_add_u32 m0, s68, 32768
  s_nop 0
  buffer_load_dwordx4 v196, s[28:31], s67 offen offset:0 nt lds
  buffer_load_dwordx4 v197, s[28:31], s67 offen offset:1024 nt lds
  s_add_u32 m0, s68, 40960
  s_nop 0
  buffer_load_dwordx4 v196, s[32:35], s69 offen offset:0 nt lds
  buffer_load_dwordx4 v197, s[32:35], s69 offen offset:1024 nt lds
  s_mov_b32 s69, s67
  s_add_u32 s67, s67, 8192
  s_add_u32 m0, s68, 49152
  s_nop 0
  buffer_load_dwordx4 v196, s[28:31], s67 offen offset:0 nt lds
  buffer_load_dwordx4 v197, s[28:31], s67 offen offset:1024 nt lds
  s_add_u32 m0, s68, 57344
  s_nop 0
  buffer_load_dwordx4 v196, s[32:35], s69 offen offset:0 nt lds
  buffer_load_dwordx4 v197, s[32:35], s69 offen offset:1024 nt lds
  s_mov_b32 s69, s67
  s_add_u32 s67, s67, 8192
  s_waitcnt vmcnt(0)
  s_barrier
  ds_read_b128 a[64:67], v184 offset:0
  ds_read_b128 a[68:71], v185 offset:0
  ds_read_b128 a[72:75], v186 offset:0
  ds_read_b128 a[76:79], v187 offset:0
  ds_read_b128 a[80:83], v184 offset:4096
  ds_read_b128 a[84:87], v185 offset:4096
  ds_read_b128 a[88:91], v186 offset:4096
  ds_read_b128 a[92:95], v187 offset:4096
  s_waitcnt lgkmcnt(0)
  s_mov_b32 s7, 1
  s_branch L_att_units

.section .rodata,"a"
.p2align 6
.amdhsa_kernel standalone__mha_block_cached__near_ridge_kernel
  .amdhsa_next_free_vgpr 512
  .amdhsa_next_free_sgpr 102
  .amdhsa_accum_offset 256
  .amdhsa_group_segment_fixed_size 0
  .amdhsa_kernarg_size 64
  .amdhsa_user_sgpr_count 2
  .amdhsa_user_sgpr_kernarg_segment_ptr 1
  .amdhsa_system_sgpr_workgroup_id_x 1
.end_amdhsa_kernel
```
